```python
import torch

def _softmax(x, axis=-1):
    return torch.softmax(x, dim=axis)
def _gelu(x):
    return torch.nn.functional.gelu(x, approximate="tanh")
def _silu(x):
    return torch.nn.functional.silu(x)
def _sigmoid(x):
    return torch.sigmoid(x)
def _layernorm(x, axis=-1, eps=1e-5):
    m = x.mean(dim=axis, keepdim=True)
    v = x.var(dim=axis, keepdim=True, unbiased=False)
    return (x - m) / torch.sqrt(v + eps)
def _scatter_add(tgt, idx, src, axis=0):
    return tgt.clone().index_add_(axis, idx, src)
def _segment_sum(src, seg, n):
    out = torch.zeros((n,) + src.shape[1:], dtype=src.dtype)
    return out.index_add_(0, seg, src)
def _pad(x, pw):
    flat = tuple(v for pair in reversed(pw) for v in pair)
    return torch.nn.functional.pad(x, flat)

kernel_name = 'parallel_sum__gqa_block_cached__mixer_token_mlp__decode'

def setup_inputs():

    _w = (lambda a: (lambda t: t.to(torch.bfloat16) if t.is_floating_point() else t)(torch.as_tensor(a)))
    def _A_setup():
        B, Sq, D = 4, 1, 512
        Hq, Hkv, Sk, Dh = 32, 32, 8192, 128
        assert Hq % Hkv == 0, (Hq, Hkv)
        return {
            "x": _w((lambda *s: torch.randn(*s, dtype=torch.bfloat16) * 0.05)(B, Sq, D)),
            "k_cache": _w((lambda *s: torch.randn(*s, dtype=torch.bfloat16) * 3.2)(B, Hkv, Sk, Dh)),
            "v_cache": _w((lambda *s: torch.randn(*s, dtype=torch.bfloat16) * 0.8)(B, Hkv, Sk, Dh)),
            "wq": _w((lambda *s: torch.randn(*s, dtype=torch.bfloat16) * 3.2)(D, Hq * Dh) * (D ** -0.5)),
            "wo": _w((lambda *s: torch.randn(*s, dtype=torch.bfloat16) * 0.8)(Hq * Dh, D) * ((Hq * Dh) ** -0.5)),
        }
    _A_in = _A_setup()

    def _B_setup():
        B, S, D, F = 4, 1, 512, 1376
        return {
            "x": _w((lambda *s: torch.randn(*s, dtype=torch.bfloat16) * 0.05)(B, S, D)),
            "w1": _w((lambda *s: torch.randn(*s, dtype=torch.bfloat16) * 1.6)(S, F) * (S ** -0.5)),
            "b1": _w((lambda *s: torch.randn(*s, dtype=torch.bfloat16) * 1.6)(F) * 0.02),
            "w2": _w((lambda *s: torch.randn(*s, dtype=torch.bfloat16) * 1.6)(F, S) * (F ** -0.5)),
            "b2": _w((lambda *s: torch.randn(*s, dtype=torch.bfloat16) * 0.8)(S) * 0.02),
        }
    _B_in = _B_setup()

    return {
        "A_x": _A_in["x"],
        "A_k_cache": _A_in["k_cache"],
        "A_v_cache": _A_in["v_cache"],
        "A_wq": _A_in["wq"],
        "A_wo": _A_in["wo"],
        "B_x": _B_in["x"],
        "B_w1": _B_in["w1"],
        "B_b1": _B_in["b1"],
        "B_w2": _B_in["w2"],
        "B_b2": _B_in["b2"],
    }

def reference(A_x, A_k_cache, A_v_cache, A_wq, A_wo, B_x, B_w1, B_b1, B_w2, B_b2):
    def _A_ref(x, k_cache, v_cache, wq, wo):
        B, Sq, D = x.shape
        Hq, Dh = 32, 128
        Hkv = k_cache.shape[1]
        rep = Hq // Hkv
        q = (lambda x, *d: x.permute(*d))((x @ wq).reshape(B, Sq, Hq, Dh), 0, 2, 1, 3)
        k = (lambda x, n, axis: torch.repeat_interleave(x, n, dim=axis))(k_cache, rep, axis=1)
        v = (lambda x, n, axis: torch.repeat_interleave(x, n, dim=axis))(v_cache, rep, axis=1)
        scores = torch.einsum("bhqd,bhkd->bhqk", q, k) * (Dh ** -0.5)
        p = _softmax(scores, axis=-1)
        o = torch.einsum("bhqk,bhkd->bhqd", p, v)
        return (lambda x, *d: x.permute(*d))(o, 0, 2, 1, 3).reshape(B, Sq, Hq * Dh) @ wo

    def _B_ref(x, w1, b1, w2, b2):
        B, S, D = x.shape
        h = _layernorm(x, axis=-1)
        u = torch.einsum("bsd,sf->bdf", h, w1) + b1
        u = _gelu(u)
        y = torch.einsum("bdf,fs->bds", u, w2) + b2
        return (lambda x, *d: x.permute(*d))(y, 0, 2, 1)

    x = A_x
    xn = _layernorm(x, axis=-1)
    return x + _A_ref(xn, A_k_cache, A_v_cache, A_wq, A_wo) + _B_ref(xn, B_w1, B_b1, B_w2, B_b2)
```

```asm
; @launch grid=(256,1,1) block=(512,1,1) lds=151808
.amdgcn_target "amdgcn-amd-amdhsa--gfx950"
.text
.globl parallel_sum__gqa_block_cached__mixer_token_mlp__decode_kernel
.p2align 8
.type parallel_sum__gqa_block_cached__mixer_token_mlp__decode_kernel,@function
parallel_sum__gqa_block_cached__mixer_token_mlp__decode_kernel:
    s_load_dwordx16 s[32:47], s[0:1], 0
    s_cmpk_ge_u32 s2, 256
    s_cbranch_scc1 L_end
    v_readfirstlane_b32 s20, v0
    s_and_b32 s22, s2, 31
    s_lshr_b32 s15, s2, 5
    s_bitcmp1_b32 s20, 8
    s_cbranch_scc1 L_helper
    s_lshl3_add_u32 s16, s22, s15
    s_lshl_b32 s16, s16, 10
    s_addk_i32 s16, 256
    v_add_lshl_u32 v3, v0, s16, 4
    v_add_u32 v4, 0x2000, v3
    s_lshl_b32 s16, s15, 8
    s_add_u32 s16, s16, s20
    s_lshl3_add_u32 s16, s16, s22
    s_lshl_b32 s16, s16, 4
    v_and_b32 v6, 15, v0
    s_waitcnt lgkmcnt(0)
    global_load_dwordx4 v[208:211], v3, s[40:41] offset:-4096
    global_load_dwordx4 v[212:215], v3, s[40:41] offset:0
    global_load_dwordx4 v[216:219], v4, s[40:41] offset:-4096
    global_load_dwordx4 v[220:223], v4, s[40:41] offset:0
    v_bfe_u32 v5, v0, 4, 2
    v_lshl_add_u32 v5, v5, 9, v6
    v_add_lshl_u32 v5, v5, s16, 4
    global_load_dwordx4 v[192:195], v5, s[38:39]
    v_add_u32 v5, 0x8000, v5
    global_load_dwordx4 v[196:199], v5, s[38:39]
    v_add_u32 v5, 0x8000, v5
    global_load_dwordx4 v[200:203], v5, s[38:39]
    v_add_u32 v5, 0x8000, v5
    global_load_dwordx4 v[204:207], v5, s[38:39]
    s_lshr_b32 s21, s2, 6
    s_lshl_b32 s27, s21, 5
    s_or_b32 s27, s27, s22
    s_and_b32 s23, s2, 32
    s_lshl_b32 s14, s27, 21
    s_lshr_b32 s15, s20, 7
    s_mulk_i32 s15, 6
    s_add_u32 s15, s15, s23
    s_lshl_b32 s15, s15, 10
    v_lshl_add_u32 v2, v0, 4, s15
    s_mov_b32 s11, 0x20000
    s_mov_b32 s25, 0
    s_lshl_b32 s10, s11, 4
    s_add_u32 s8, s34, s14
    s_addc_u32 s9, s35, 0
L_stream:
    s_setprio 2
    s_waitcnt vmcnt(4)
    buffer_load_dwordx4 v[32:35], v2, s[8:11], s25 offen nt
    s_waitcnt vmcnt(4)
    buffer_load_dwordx4 v[36:39], v2, s[8:11], s25 offen offset:2048 nt
    s_addk_i32 s25, 4096
    s_waitcnt vmcnt(4)
    buffer_load_dwordx4 v[40:43], v2, s[8:11], s25 offen nt
    s_waitcnt vmcnt(4)
    buffer_load_dwordx4 v[44:47], v2, s[8:11], s25 offen offset:2048 nt
    s_addk_i32 s25, 12288
    s_waitcnt vmcnt(4)
    buffer_load_dwordx4 v[48:51], v2, s[8:11], s25 offen nt
    s_waitcnt vmcnt(4)
    buffer_load_dwordx4 v[52:55], v2, s[8:11], s25 offen offset:2048 nt
    s_addk_i32 s25, 4096
    s_waitcnt vmcnt(4)
    buffer_load_dwordx4 v[56:59], v2, s[8:11], s25 offen nt
    s_waitcnt vmcnt(4)
    buffer_load_dwordx4 v[60:63], v2, s[8:11], s25 offen offset:2048 nt
    s_add_u32 s25, s25, 45056
    s_waitcnt vmcnt(4)
    buffer_load_dwordx4 v[64:67], v2, s[8:11], s25 offen nt
    s_waitcnt vmcnt(4)
    buffer_load_dwordx4 v[68:71], v2, s[8:11], s25 offen offset:2048 nt
    s_addk_i32 s25, 4096
    s_waitcnt vmcnt(4)
    buffer_load_dwordx4 v[72:75], v2, s[8:11], s25 offen nt
    s_waitcnt vmcnt(4)
    buffer_load_dwordx4 v[76:79], v2, s[8:11], s25 offen offset:2048 nt
    s_addk_i32 s25, 12288
    s_waitcnt vmcnt(4)
    buffer_load_dwordx4 v[80:83], v2, s[8:11], s25 offen nt
    s_waitcnt vmcnt(4)
    buffer_load_dwordx4 v[84:87], v2, s[8:11], s25 offen offset:2048 nt
    s_addk_i32 s25, 4096
    s_waitcnt vmcnt(4)
    buffer_load_dwordx4 v[88:91], v2, s[8:11], s25 offen nt
    s_waitcnt vmcnt(4)
    buffer_load_dwordx4 v[92:95], v2, s[8:11], s25 offen offset:2048 nt
    s_add_u32 s25, s25, 45056
    s_and_b32 s25, s25, 2097151
    s_waitcnt vmcnt(4)
    buffer_load_dwordx4 v[96:99], v2, s[8:11], s25 offen nt
    s_waitcnt vmcnt(4)
    buffer_load_dwordx4 v[100:103], v2, s[8:11], s25 offen offset:2048 nt
    s_addk_i32 s25, 4096
    s_waitcnt vmcnt(4)
    buffer_load_dwordx4 v[104:107], v2, s[8:11], s25 offen nt
    s_waitcnt vmcnt(4)
    buffer_load_dwordx4 v[108:111], v2, s[8:11], s25 offen offset:2048 nt
    s_addk_i32 s25, 12288
    s_waitcnt vmcnt(4)
    buffer_load_dwordx4 v[112:115], v2, s[8:11], s25 offen nt
    s_waitcnt vmcnt(4)
    buffer_load_dwordx4 v[116:119], v2, s[8:11], s25 offen offset:2048 nt
    s_addk_i32 s25, 4096
    s_waitcnt vmcnt(4)
    buffer_load_dwordx4 v[120:123], v2, s[8:11], s25 offen nt
    s_waitcnt vmcnt(4)
    buffer_load_dwordx4 v[124:127], v2, s[8:11], s25 offen offset:2048 nt
    s_add_u32 s25, s25, 45056
    s_waitcnt vmcnt(4)
    buffer_load_dwordx4 v[128:131], v2, s[8:11], s25 offen nt
    s_load_dwordx8 s[48:55], s[0:1], 64
    s_load_dwordx2 s[56:57], s[0:1], 96
    s_lshr_b32 s20, s20, 6
    v_and_b32 v1, 63, v0
    s_bfe_u32 s23, s2, 0x10005
    s_add_u32 s12, s36, s14
    s_addc_u32 s13, s37, 0
    s_lshl_b32 s16, s20, 12
    v_lshrrev_b32 v12, 4, v1
    v_lshlrev_b32 v12, 6, v12
    v_and_b32 v13, 12, v1
    v_add3_u32 v3, v12, v13, s16
    v_lshl_add_u32 v4, v1, 2, s16
    v_and_b32 v5, 15, v1
    v_lshlrev_b32 v5, 5, v5
    s_lshl_b32 s17, s20, 15
    s_add_u32 s17, s17, 20736
    s_mov_b32 m0, s17
    s_waitcnt vmcnt(4)
    buffer_load_dwordx4 v[132:135], v2, s[8:11], s25 offen offset:2048 nt
    s_addk_i32 s25, 4096
    s_waitcnt vmcnt(4)
    buffer_load_dwordx4 v[136:139], v2, s[8:11], s25 offen nt
    s_waitcnt vmcnt(4)
    buffer_load_dwordx4 v[140:143], v2, s[8:11], s25 offen offset:2048 nt
    s_addk_i32 s25, 12288
    s_waitcnt vmcnt(4)
    buffer_load_dwordx4 v[144:147], v2, s[8:11], s25 offen nt
    s_waitcnt vmcnt(4)
    buffer_load_dwordx4 v[148:151], v2, s[8:11], s25 offen offset:2048 nt
    s_addk_i32 s25, 4096
    s_waitcnt vmcnt(4)
    buffer_load_dwordx4 v[152:155], v2, s[8:11], s25 offen nt
    s_waitcnt vmcnt(4)
    buffer_load_dwordx4 v[156:159], v2, s[8:11], s25 offen offset:2048 nt
    s_add_u32 s25, s25, 45056
    s_and_b32 s25, s25, 2097151
    s_waitcnt vmcnt(4)
    buffer_load_dwordx4 v[160:163], v2, s[8:11], s25 offen nt
    s_waitcnt vmcnt(4)
    buffer_load_dwordx4 v[164:167], v2, s[8:11], s25 offen offset:2048 nt
    s_addk_i32 s25, 4096
    s_waitcnt vmcnt(4)
    buffer_load_dwordx4 v[168:171], v2, s[8:11], s25 offen nt
    s_waitcnt vmcnt(4)
    buffer_load_dwordx4 v[172:175], v2, s[8:11], s25 offen offset:2048 nt
    s_addk_i32 s25, 12288
    s_waitcnt vmcnt(4)
    buffer_load_dwordx4 v[176:179], v2, s[8:11], s25 offen nt
    s_waitcnt vmcnt(4)
    buffer_load_dwordx4 v[180:183], v2, s[8:11], s25 offen offset:2048 nt
    s_addk_i32 s25, 4096
    s_waitcnt vmcnt(4)
    buffer_load_dwordx4 v[184:187], v2, s[8:11], s25 offen nt
    s_waitcnt vmcnt(4)
    buffer_load_dwordx4 v[188:191], v2, s[8:11], s25 offen offset:2048 nt
    s_add_u32 s25, s25, 45056
    s_waitcnt vmcnt(4)
    buffer_load_dwordx4 v[192:195], v2, s[8:11], s25 offen nt
    s_waitcnt vmcnt(4)
    buffer_load_dwordx4 v[196:199], v2, s[8:11], s25 offen offset:2048 nt
    s_addk_i32 s25, 4096
    s_waitcnt vmcnt(4)
    buffer_load_dwordx4 v[200:203], v2, s[8:11], s25 offen nt
    s_waitcnt vmcnt(4)
    buffer_load_dwordx4 v[204:207], v2, s[8:11], s25 offen offset:2048 nt
    s_addk_i32 s25, 12288
    s_waitcnt vmcnt(4)
    buffer_load_dwordx4 v[208:211], v2, s[8:11], s25 offen nt
    s_waitcnt vmcnt(4)
    buffer_load_dwordx4 v[212:215], v2, s[8:11], s25 offen offset:2048 nt
    s_addk_i32 s25, 4096
    s_waitcnt vmcnt(4)
    buffer_load_dwordx4 v[216:219], v2, s[8:11], s25 offen nt
    s_waitcnt vmcnt(4)
    buffer_load_dwordx4 v[220:223], v2, s[8:11], s25 offen offset:2048 nt
    s_add_u32 s25, s25, 45056
    s_and_b32 s25, s25, 2097151
    s_waitcnt vmcnt(4)
    buffer_load_dwordx4 v2, s[8:11], s25 offen nt lds
    s_addk_i32 m0, 1024
    s_addk_i32 s25, 2048
    s_waitcnt vmcnt(4)
    buffer_load_dwordx4 v2, s[8:11], s25 offen nt lds
    s_addk_i32 m0, 1024
    s_addk_i32 s25, 2048
    s_waitcnt vmcnt(4)
    buffer_load_dwordx4 v2, s[8:11], s25 offen nt lds
    s_addk_i32 m0, 1024
    s_addk_i32 s25, 2048
    s_waitcnt vmcnt(4)
    buffer_load_dwordx4 v2, s[8:11], s25 offen nt lds
    s_addk_i32 m0, 1024
    s_addk_i32 s25, 10240
    s_waitcnt vmcnt(4)
    buffer_load_dwordx4 v2, s[8:11], s25 offen nt lds
    s_addk_i32 m0, 1024
    s_addk_i32 s25, 2048
    s_waitcnt vmcnt(4)
    buffer_load_dwordx4 v2, s[8:11], s25 offen nt lds
    s_addk_i32 m0, 1024
    s_addk_i32 s25, 2048
    s_waitcnt vmcnt(4)
    buffer_load_dwordx4 v2, s[8:11], s25 offen nt lds
    s_addk_i32 m0, 1024
    s_addk_i32 s25, 2048
    s_waitcnt vmcnt(4)
    buffer_load_dwordx4 v2, s[8:11], s25 offen nt lds
    s_addk_i32 m0, 1024
    s_add_u32 s25, s25, 43008
    s_waitcnt vmcnt(4)
    buffer_load_dwordx4 v2, s[8:11], s25 offen nt lds
    s_addk_i32 m0, 1024
    s_addk_i32 s25, 2048
    s_waitcnt vmcnt(4)
    buffer_load_dwordx4 v2, s[8:11], s25 offen nt lds
    s_addk_i32 m0, 1024
    s_addk_i32 s25, 2048
    s_waitcnt vmcnt(4)
    buffer_load_dwordx4 v2, s[8:11], s25 offen nt lds
    s_addk_i32 m0, 1024
    s_addk_i32 s25, 2048
    s_waitcnt vmcnt(4)
    buffer_load_dwordx4 v2, s[8:11], s25 offen nt lds
    s_addk_i32 m0, 1024
    s_addk_i32 s25, 10240
    s_waitcnt vmcnt(4)
    buffer_load_dwordx4 v2, s[8:11], s25 offen nt lds
    s_addk_i32 m0, 1024
    s_addk_i32 s25, 2048
    s_waitcnt vmcnt(4)
    buffer_load_dwordx4 v2, s[8:11], s25 offen nt lds
    s_addk_i32 m0, 1024
    s_addk_i32 s25, 2048
    s_waitcnt vmcnt(4)
    buffer_load_dwordx4 v2, s[8:11], s25 offen nt lds
    s_addk_i32 m0, 1024
    s_addk_i32 s25, 2048
    s_waitcnt lgkmcnt(0)
    s_barrier
    s_waitcnt vmcnt(4)
    buffer_load_dwordx4 v2, s[8:11], s25 offen nt lds
    s_addk_i32 m0, 1024
    s_add_u32 s25, s25, 43008
    s_and_b32 s25, s25, 2097151
    ds_read_b128 v[6:9], v5 offset:16384
    ds_read_b128 v[10:13], v5 offset:16400
    ds_read_b128 v[16:19], v5 offset:16896
    ds_read_b128 v[20:23], v5 offset:16912
    ds_read_b128 v[24:27], v5 offset:17408
    ds_read_b128 v[28:31], v5 offset:17424
    s_waitcnt lgkmcnt(2)
    v_pk_add_f32 v[6:7], v[6:7], v[16:17]
    v_pk_add_f32 v[8:9], v[8:9], v[18:19]
    v_pk_add_f32 v[10:11], v[10:11], v[20:21]
    v_pk_add_f32 v[12:13], v[12:13], v[22:23]
    ds_read_b128 v[16:19], v5 offset:17920
    ds_read_b128 v[20:23], v5 offset:17936
    v_mov_b32 v5, 0xff800000
    s_waitcnt lgkmcnt(0)
    v_pk_add_f32 v[24:25], v[24:25], v[16:17]
    v_pk_add_f32 v[26:27], v[26:27], v[18:19]
    v_pk_add_f32 v[28:29], v[28:29], v[20:21]
    v_pk_add_f32 v[30:31], v[30:31], v[22:23]
    v_pk_add_f32 v[6:7], v[6:7], v[24:25]
    v_pk_add_f32 v[8:9], v[8:9], v[26:27]
    v_pk_add_f32 v[10:11], v[10:11], v[28:29]
    v_pk_add_f32 v[12:13], v[12:13], v[30:31]
    v_cvt_pk_bf16_f32 v14, v6, v7
    v_cvt_pk_bf16_f32 v15, v8, v9
    v_cvt_pk_bf16_f32 v16, v10, v11
    v_cvt_pk_bf16_f32 v17, v12, v13
    v_lshl_add_u32 v18, v1, 4, s17
    s_waitcnt vmcnt(60)
    v_dot2_f32_bf16 v6, v32, v14, 0
    v_dot2_f32_bf16 v7, v36, v14, 0
    v_dot2_f32_bf16 v8, v40, v14, 0
    v_dot2_f32_bf16 v9, v44, v14, 0
    v_dot2_f32_bf16 v6, v33, v15, v6
    v_dot2_f32_bf16 v7, v37, v15, v7
    v_dot2_f32_bf16 v8, v41, v15, v8
    v_dot2_f32_bf16 v9, v45, v15, v9
    v_dot2_f32_bf16 v6, v34, v16, v6
    v_dot2_f32_bf16 v7, v38, v16, v7
    v_dot2_f32_bf16 v8, v42, v16, v8
    v_dot2_f32_bf16 v9, v46, v16, v9
    v_dot2_f32_bf16 v6, v35, v17, v6
    v_dot2_f32_bf16 v7, v39, v17, v7
    v_dot2_f32_bf16 v8, v43, v17, v8
    v_dot2_f32_bf16 v9, v47, v17, v9
    s_waitcnt vmcnt(4)
    buffer_load_dwordx4 v[32:35], v2, s[8:11], s25 offen nt
    s_waitcnt vmcnt(57)
    v_dot2_f32_bf16 v20, v48, v14, 0
    v_dot2_f32_bf16 v21, v52, v14, 0
    v_add_f32_dpp v6, v6, v6 row_ror:8 row_mask:0xf bank_mask:0xf
    v_dot2_f32_bf16 v22, v56, v14, 0
    v_add_f32_dpp v7, v7, v7 row_ror:8 row_mask:0xf bank_mask:0xf
    v_dot2_f32_bf16 v23, v60, v14, 0
    v_dot2_f32_bf16 v20, v49, v15, v20
    v_add_f32_dpp v6, v8, v8 row_ror:8 row_mask:0xf bank_mask:0xc
    v_dot2_f32_bf16 v21, v53, v15, v21
    v_add_f32_dpp v7, v9, v9 row_ror:8 row_mask:0xf bank_mask:0xc
    v_dot2_f32_bf16 v22, v57, v15, v22
    v_dot2_f32_bf16 v23, v61, v15, v23
    v_add_f32_dpp v10, v6, v6 row_half_mirror row_mask:0xf bank_mask:0xf
    v_dot2_f32_bf16 v20, v50, v16, v20
    v_dot2_f32_bf16 v21, v54, v16, v21
    v_add_f32_dpp v10, v7, v7 row_half_mirror row_mask:0xf bank_mask:0xa
    v_dot2_f32_bf16 v22, v58, v16, v22
    v_dot2_f32_bf16 v23, v62, v16, v23
    v_add_f32_dpp v10, v10, v10 quad_perm:[1,0,3,2] row_mask:0xf bank_mask:0xf
    v_dot2_f32_bf16 v20, v51, v17, v20
    v_dot2_f32_bf16 v21, v55, v17, v21
    v_add_f32_dpp v10, v10, v10 quad_perm:[2,3,0,1] row_mask:0xf bank_mask:0xf
    v_dot2_f32_bf16 v22, v59, v17, v22
    ds_write_b32 v3, v10 offset:0
    v_dot2_f32_bf16 v23, v63, v17, v23
    v_max_f32 v5, v5, v10
    s_waitcnt vmcnt(4)
    buffer_load_dwordx4 v[36:39], v2, s[8:11], s25 offen offset:2048 nt
    s_addk_i32 s25, 4096
    s_waitcnt vmcnt(54)
    v_dot2_f32_bf16 v6, v64, v14, 0
    v_dot2_f32_bf16 v7, v68, v14, 0
    v_add_f32_dpp v20, v20, v20 row_ror:8 row_mask:0xf bank_mask:0xf
    v_dot2_f32_bf16 v8, v72, v14, 0
    v_add_f32_dpp v21, v21, v21 row_ror:8 row_mask:0xf bank_mask:0xf
    v_dot2_f32_bf16 v9, v76, v14, 0
    v_dot2_f32_bf16 v6, v65, v15, v6
    v_add_f32_dpp v20, v22, v22 row_ror:8 row_mask:0xf bank_mask:0xc
    v_dot2_f32_bf16 v7, v69, v15, v7
    v_add_f32_dpp v21, v23, v23 row_ror:8 row_mask:0xf bank_mask:0xc
    v_dot2_f32_bf16 v8, v73, v15, v8
    v_dot2_f32_bf16 v9, v77, v15, v9
    v_add_f32_dpp v24, v20, v20 row_half_mirror row_mask:0xf bank_mask:0xf
    v_dot2_f32_bf16 v6, v66, v16, v6
    v_dot2_f32_bf16 v7, v70, v16, v7
    v_add_f32_dpp v24, v21, v21 row_half_mirror row_mask:0xf bank_mask:0xa
    v_dot2_f32_bf16 v8, v74, v16, v8
    v_dot2_f32_bf16 v9, v78, v16, v9
    v_add_f32_dpp v24, v24, v24 quad_perm:[1,0,3,2] row_mask:0xf bank_mask:0xf
    v_dot2_f32_bf16 v6, v67, v17, v6
    v_dot2_f32_bf16 v7, v71, v17, v7
    v_add_f32_dpp v24, v24, v24 quad_perm:[2,3,0,1] row_mask:0xf bank_mask:0xf
    v_dot2_f32_bf16 v8, v75, v17, v8
    ds_write_b32 v3, v24 offset:16
    v_dot2_f32_bf16 v9, v79, v17, v9
    v_max_f32 v5, v5, v24
    s_waitcnt vmcnt(4)
    buffer_load_dwordx4 v[40:43], v2, s[8:11], s25 offen nt
    s_waitcnt vmcnt(51)
    v_dot2_f32_bf16 v20, v80, v14, 0
    v_dot2_f32_bf16 v21, v84, v14, 0
    v_add_f32_dpp v6, v6, v6 row_ror:8 row_mask:0xf bank_mask:0xf
    v_dot2_f32_bf16 v22, v88, v14, 0
    v_add_f32_dpp v7, v7, v7 row_ror:8 row_mask:0xf bank_mask:0xf
    v_dot2_f32_bf16 v23, v92, v14, 0
    v_dot2_f32_bf16 v20, v81, v15, v20
    v_add_f32_dpp v6, v8, v8 row_ror:8 row_mask:0xf bank_mask:0xc
    v_dot2_f32_bf16 v21, v85, v15, v21
    v_add_f32_dpp v7, v9, v9 row_ror:8 row_mask:0xf bank_mask:0xc
    v_dot2_f32_bf16 v22, v89, v15, v22
    v_dot2_f32_bf16 v23, v93, v15, v23
    v_add_f32_dpp v10, v6, v6 row_half_mirror row_mask:0xf bank_mask:0xf
    v_dot2_f32_bf16 v20, v82, v16, v20
    v_dot2_f32_bf16 v21, v86, v16, v21
    v_add_f32_dpp v10, v7, v7 row_half_mirror row_mask:0xf bank_mask:0xa
    v_dot2_f32_bf16 v22, v90, v16, v22
    v_dot2_f32_bf16 v23, v94, v16, v23
    v_add_f32_dpp v10, v10, v10 quad_perm:[1,0,3,2] row_mask:0xf bank_mask:0xf
    v_dot2_f32_bf16 v20, v83, v17, v20
    v_dot2_f32_bf16 v21, v87, v17, v21
    v_add_f32_dpp v10, v10, v10 quad_perm:[2,3,0,1] row_mask:0xf bank_mask:0xf
    v_dot2_f32_bf16 v22, v91, v17, v22
    ds_write_b32 v3, v10 offset:32
    v_dot2_f32_bf16 v23, v95, v17, v23
    v_max_f32 v5, v5, v10
    s_waitcnt vmcnt(4)
    buffer_load_dwordx4 v[44:47], v2, s[8:11], s25 offen offset:2048 nt
    s_addk_i32 s25, 12288
    s_waitcnt vmcnt(48)
    v_dot2_f32_bf16 v6, v96, v14, 0
    v_dot2_f32_bf16 v7, v100, v14, 0
    v_add_f32_dpp v20, v20, v20 row_ror:8 row_mask:0xf bank_mask:0xf
    v_dot2_f32_bf16 v8, v104, v14, 0
    v_add_f32_dpp v21, v21, v21 row_ror:8 row_mask:0xf bank_mask:0xf
    v_dot2_f32_bf16 v9, v108, v14, 0
    v_dot2_f32_bf16 v6, v97, v15, v6
    v_add_f32_dpp v20, v22, v22 row_ror:8 row_mask:0xf bank_mask:0xc
    v_dot2_f32_bf16 v7, v101, v15, v7
    v_add_f32_dpp v21, v23, v23 row_ror:8 row_mask:0xf bank_mask:0xc
    v_dot2_f32_bf16 v8, v105, v15, v8
    v_dot2_f32_bf16 v9, v109, v15, v9
    v_add_f32_dpp v24, v20, v20 row_half_mirror row_mask:0xf bank_mask:0xf
    v_dot2_f32_bf16 v6, v98, v16, v6
    v_dot2_f32_bf16 v7, v102, v16, v7
    v_add_f32_dpp v24, v21, v21 row_half_mirror row_mask:0xf bank_mask:0xa
    v_dot2_f32_bf16 v8, v106, v16, v8
    v_dot2_f32_bf16 v9, v110, v16, v9
    v_add_f32_dpp v24, v24, v24 quad_perm:[1,0,3,2] row_mask:0xf bank_mask:0xf
    v_dot2_f32_bf16 v6, v99, v17, v6
    v_dot2_f32_bf16 v7, v103, v17, v7
    v_add_f32_dpp v24, v24, v24 quad_perm:[2,3,0,1] row_mask:0xf bank_mask:0xf
    v_dot2_f32_bf16 v8, v107, v17, v8
    ds_write_b32 v3, v24 offset:48
    v_dot2_f32_bf16 v9, v111, v17, v9
    v_max_f32 v5, v5, v24
    s_waitcnt vmcnt(4)
    buffer_load_dwordx4 v[48:51], v2, s[8:11], s25 offen nt
    s_waitcnt vmcnt(45)
    v_dot2_f32_bf16 v20, v112, v14, 0
    v_dot2_f32_bf16 v21, v116, v14, 0
    v_add_f32_dpp v6, v6, v6 row_ror:8 row_mask:0xf bank_mask:0xf
    v_dot2_f32_bf16 v22, v120, v14, 0
    v_add_f32_dpp v7, v7, v7 row_ror:8 row_mask:0xf bank_mask:0xf
    v_dot2_f32_bf16 v23, v124, v14, 0
    v_dot2_f32_bf16 v20, v113, v15, v20
    v_add_f32_dpp v6, v8, v8 row_ror:8 row_mask:0xf bank_mask:0xc
    v_dot2_f32_bf16 v21, v117, v15, v21
    v_add_f32_dpp v7, v9, v9 row_ror:8 row_mask:0xf bank_mask:0xc
    v_dot2_f32_bf16 v22, v121, v15, v22
    v_dot2_f32_bf16 v23, v125, v15, v23
    v_add_f32_dpp v10, v6, v6 row_half_mirror row_mask:0xf bank_mask:0xf
    v_dot2_f32_bf16 v20, v114, v16, v20
    v_dot2_f32_bf16 v21, v118, v16, v21
    v_add_f32_dpp v10, v7, v7 row_half_mirror row_mask:0xf bank_mask:0xa
    v_dot2_f32_bf16 v22, v122, v16, v22
    v_dot2_f32_bf16 v23, v126, v16, v23
    v_add_f32_dpp v10, v10, v10 quad_perm:[1,0,3,2] row_mask:0xf bank_mask:0xf
    v_dot2_f32_bf16 v20, v115, v17, v20
    v_dot2_f32_bf16 v21, v119, v17, v21
    v_add_f32_dpp v10, v10, v10 quad_perm:[2,3,0,1] row_mask:0xf bank_mask:0xf
    v_dot2_f32_bf16 v22, v123, v17, v22
    ds_write_b32 v3, v10 offset:256
    v_dot2_f32_bf16 v23, v127, v17, v23
    v_max_f32 v5, v5, v10
    s_waitcnt vmcnt(4)
    buffer_load_dwordx4 v[52:55], v2, s[8:11], s25 offen offset:2048 nt
    s_addk_i32 s25, 4096
    s_waitcnt vmcnt(42)
    v_dot2_f32_bf16 v6, v128, v14, 0
    v_dot2_f32_bf16 v7, v132, v14, 0
    v_add_f32_dpp v20, v20, v20 row_ror:8 row_mask:0xf bank_mask:0xf
    v_dot2_f32_bf16 v8, v136, v14, 0
    v_add_f32_dpp v21, v21, v21 row_ror:8 row_mask:0xf bank_mask:0xf
    v_dot2_f32_bf16 v9, v140, v14, 0
    v_dot2_f32_bf16 v6, v129, v15, v6
    v_add_f32_dpp v20, v22, v22 row_ror:8 row_mask:0xf bank_mask:0xc
    v_dot2_f32_bf16 v7, v133, v15, v7
    v_add_f32_dpp v21, v23, v23 row_ror:8 row_mask:0xf bank_mask:0xc
    v_dot2_f32_bf16 v8, v137, v15, v8
    v_dot2_f32_bf16 v9, v141, v15, v9
    v_add_f32_dpp v24, v20, v20 row_half_mirror row_mask:0xf bank_mask:0xf
    v_dot2_f32_bf16 v6, v130, v16, v6
    v_dot2_f32_bf16 v7, v134, v16, v7
    v_add_f32_dpp v24, v21, v21 row_half_mirror row_mask:0xf bank_mask:0xa
    v_dot2_f32_bf16 v8, v138, v16, v8
    v_dot2_f32_bf16 v9, v142, v16, v9
    v_add_f32_dpp v24, v24, v24 quad_perm:[1,0,3,2] row_mask:0xf bank_mask:0xf
    v_dot2_f32_bf16 v6, v131, v17, v6
    v_dot2_f32_bf16 v7, v135, v17, v7
    v_add_f32_dpp v24, v24, v24 quad_perm:[2,3,0,1] row_mask:0xf bank_mask:0xf
    v_dot2_f32_bf16 v8, v139, v17, v8
    ds_write_b32 v3, v24 offset:272
    v_dot2_f32_bf16 v9, v143, v17, v9
    v_max_f32 v5, v5, v24
    s_waitcnt vmcnt(4)
    buffer_load_dwordx4 v[56:59], v2, s[8:11], s25 offen nt
    s_waitcnt vmcnt(39)
    v_dot2_f32_bf16 v20, v144, v14, 0
    v_dot2_f32_bf16 v21, v148, v14, 0
    v_add_f32_dpp v6, v6, v6 row_ror:8 row_mask:0xf bank_mask:0xf
    v_dot2_f32_bf16 v22, v152, v14, 0
    v_add_f32_dpp v7, v7, v7 row_ror:8 row_mask:0xf bank_mask:0xf
    v_dot2_f32_bf16 v23, v156, v14, 0
    v_dot2_f32_bf16 v20, v145, v15, v20
    v_add_f32_dpp v6, v8, v8 row_ror:8 row_mask:0xf bank_mask:0xc
    v_dot2_f32_bf16 v21, v149, v15, v21
    v_add_f32_dpp v7, v9, v9 row_ror:8 row_mask:0xf bank_mask:0xc
    v_dot2_f32_bf16 v22, v153, v15, v22
    v_dot2_f32_bf16 v23, v157, v15, v23
    v_add_f32_dpp v10, v6, v6 row_half_mirror row_mask:0xf bank_mask:0xf
    v_dot2_f32_bf16 v20, v146, v16, v20
    v_dot2_f32_bf16 v21, v150, v16, v21
    v_add_f32_dpp v10, v7, v7 row_half_mirror row_mask:0xf bank_mask:0xa
    v_dot2_f32_bf16 v22, v154, v16, v22
    v_dot2_f32_bf16 v23, v158, v16, v23
    v_add_f32_dpp v10, v10, v10 quad_perm:[1,0,3,2] row_mask:0xf bank_mask:0xf
    v_dot2_f32_bf16 v20, v147, v17, v20
    v_dot2_f32_bf16 v21, v151, v17, v21
    v_add_f32_dpp v10, v10, v10 quad_perm:[2,3,0,1] row_mask:0xf bank_mask:0xf
    v_dot2_f32_bf16 v22, v155, v17, v22
    ds_write_b32 v3, v10 offset:288
    v_dot2_f32_bf16 v23, v159, v17, v23
    v_max_f32 v5, v5, v10
    s_waitcnt vmcnt(4)
    buffer_load_dwordx4 v[60:63], v2, s[8:11], s25 offen offset:2048 nt
    s_add_u32 s25, s25, 45056
    s_waitcnt vmcnt(36)
    v_dot2_f32_bf16 v6, v160, v14, 0
    v_dot2_f32_bf16 v7, v164, v14, 0
    v_add_f32_dpp v20, v20, v20 row_ror:8 row_mask:0xf bank_mask:0xf
    v_dot2_f32_bf16 v8, v168, v14, 0
    v_add_f32_dpp v21, v21, v21 row_ror:8 row_mask:0xf bank_mask:0xf
    v_dot2_f32_bf16 v9, v172, v14, 0
    v_dot2_f32_bf16 v6, v161, v15, v6
    v_add_f32_dpp v20, v22, v22 row_ror:8 row_mask:0xf bank_mask:0xc
    v_dot2_f32_bf16 v7, v165, v15, v7
    v_add_f32_dpp v21, v23, v23 row_ror:8 row_mask:0xf bank_mask:0xc
    v_dot2_f32_bf16 v8, v169, v15, v8
    v_dot2_f32_bf16 v9, v173, v15, v9
    v_add_f32_dpp v24, v20, v20 row_half_mirror row_mask:0xf bank_mask:0xf
    v_dot2_f32_bf16 v6, v162, v16, v6
    v_dot2_f32_bf16 v7, v166, v16, v7
    v_add_f32_dpp v24, v21, v21 row_half_mirror row_mask:0xf bank_mask:0xa
    v_dot2_f32_bf16 v8, v170, v16, v8
    v_dot2_f32_bf16 v9, v174, v16, v9
    v_add_f32_dpp v24, v24, v24 quad_perm:[1,0,3,2] row_mask:0xf bank_mask:0xf
    v_dot2_f32_bf16 v6, v163, v17, v6
    v_dot2_f32_bf16 v7, v167, v17, v7
    v_add_f32_dpp v24, v24, v24 quad_perm:[2,3,0,1] row_mask:0xf bank_mask:0xf
    v_dot2_f32_bf16 v8, v171, v17, v8
    ds_write_b32 v3, v24 offset:304
    v_dot2_f32_bf16 v9, v175, v17, v9
    v_max_f32 v5, v5, v24
    s_waitcnt vmcnt(4)
    buffer_load_dwordx4 v[64:67], v2, s[8:11], s25 offen nt
    s_waitcnt vmcnt(33)
    v_dot2_f32_bf16 v20, v176, v14, 0
    v_dot2_f32_bf16 v21, v180, v14, 0
    v_add_f32_dpp v6, v6, v6 row_ror:8 row_mask:0xf bank_mask:0xf
    v_dot2_f32_bf16 v22, v184, v14, 0
    v_add_f32_dpp v7, v7, v7 row_ror:8 row_mask:0xf bank_mask:0xf
    v_dot2_f32_bf16 v23, v188, v14, 0
    v_dot2_f32_bf16 v20, v177, v15, v20
    v_add_f32_dpp v6, v8, v8 row_ror:8 row_mask:0xf bank_mask:0xc
    v_dot2_f32_bf16 v21, v181, v15, v21
    v_add_f32_dpp v7, v9, v9 row_ror:8 row_mask:0xf bank_mask:0xc
    v_dot2_f32_bf16 v22, v185, v15, v22
    v_dot2_f32_bf16 v23, v189, v15, v23
    v_add_f32_dpp v10, v6, v6 row_half_mirror row_mask:0xf bank_mask:0xf
    v_dot2_f32_bf16 v20, v178, v16, v20
    v_dot2_f32_bf16 v21, v182, v16, v21
    v_add_f32_dpp v10, v7, v7 row_half_mirror row_mask:0xf bank_mask:0xa
    v_dot2_f32_bf16 v22, v186, v16, v22
    v_dot2_f32_bf16 v23, v190, v16, v23
    v_add_f32_dpp v10, v10, v10 quad_perm:[1,0,3,2] row_mask:0xf bank_mask:0xf
    v_dot2_f32_bf16 v20, v179, v17, v20
    v_dot2_f32_bf16 v21, v183, v17, v21
    v_add_f32_dpp v10, v10, v10 quad_perm:[2,3,0,1] row_mask:0xf bank_mask:0xf
    v_dot2_f32_bf16 v22, v187, v17, v22
    ds_write_b32 v3, v10 offset:512
    v_dot2_f32_bf16 v23, v191, v17, v23
    v_max_f32 v5, v5, v10
    s_waitcnt vmcnt(4)
    buffer_load_dwordx4 v[68:71], v2, s[8:11], s25 offen offset:2048 nt
    s_addk_i32 s25, 4096
    s_waitcnt vmcnt(30)
    v_dot2_f32_bf16 v6, v192, v14, 0
    v_dot2_f32_bf16 v7, v196, v14, 0
    v_add_f32_dpp v20, v20, v20 row_ror:8 row_mask:0xf bank_mask:0xf
    v_dot2_f32_bf16 v8, v200, v14, 0
    v_add_f32_dpp v21, v21, v21 row_ror:8 row_mask:0xf bank_mask:0xf
    v_dot2_f32_bf16 v9, v204, v14, 0
    v_dot2_f32_bf16 v6, v193, v15, v6
    v_add_f32_dpp v20, v22, v22 row_ror:8 row_mask:0xf bank_mask:0xc
    v_dot2_f32_bf16 v7, v197, v15, v7
    v_add_f32_dpp v21, v23, v23 row_ror:8 row_mask:0xf bank_mask:0xc
    v_dot2_f32_bf16 v8, v201, v15, v8
    v_dot2_f32_bf16 v9, v205, v15, v9
    v_add_f32_dpp v24, v20, v20 row_half_mirror row_mask:0xf bank_mask:0xf
    v_dot2_f32_bf16 v6, v194, v16, v6
    v_dot2_f32_bf16 v7, v198, v16, v7
    v_add_f32_dpp v24, v21, v21 row_half_mirror row_mask:0xf bank_mask:0xa
    v_dot2_f32_bf16 v8, v202, v16, v8
    v_dot2_f32_bf16 v9, v206, v16, v9
    v_add_f32_dpp v24, v24, v24 quad_perm:[1,0,3,2] row_mask:0xf bank_mask:0xf
    v_dot2_f32_bf16 v6, v195, v17, v6
    v_dot2_f32_bf16 v7, v199, v17, v7
    v_add_f32_dpp v24, v24, v24 quad_perm:[2,3,0,1] row_mask:0xf bank_mask:0xf
    v_dot2_f32_bf16 v8, v203, v17, v8
    ds_write_b32 v3, v24 offset:528
    v_dot2_f32_bf16 v9, v207, v17, v9
    v_max_f32 v5, v5, v24
    s_waitcnt vmcnt(4)
    buffer_load_dwordx4 v[72:75], v2, s[8:11], s25 offen nt
    s_waitcnt vmcnt(23)
    ds_read_b128 v[96:99], v18 offset:0
    ds_read_b128 v[100:103], v18 offset:1024
    ds_read_b128 v[104:107], v18 offset:2048
    ds_read_b128 v[108:111], v18 offset:3072
    s_waitcnt vmcnt(27)
    v_dot2_f32_bf16 v20, v208, v14, 0
    v_dot2_f32_bf16 v21, v212, v14, 0
    v_add_f32_dpp v6, v6, v6 row_ror:8 row_mask:0xf bank_mask:0xf
    v_dot2_f32_bf16 v22, v216, v14, 0
    v_add_f32_dpp v7, v7, v7 row_ror:8 row_mask:0xf bank_mask:0xf
    v_dot2_f32_bf16 v23, v220, v14, 0
    v_dot2_f32_bf16 v20, v209, v15, v20
    v_add_f32_dpp v6, v8, v8 row_ror:8 row_mask:0xf bank_mask:0xc
    v_dot2_f32_bf16 v21, v213, v15, v21
    v_add_f32_dpp v7, v9, v9 row_ror:8 row_mask:0xf bank_mask:0xc
    v_dot2_f32_bf16 v22, v217, v15, v22
    v_dot2_f32_bf16 v23, v221, v15, v23
    v_add_f32_dpp v10, v6, v6 row_half_mirror row_mask:0xf bank_mask:0xf
    v_dot2_f32_bf16 v20, v210, v16, v20
    v_dot2_f32_bf16 v21, v214, v16, v21
    v_add_f32_dpp v10, v7, v7 row_half_mirror row_mask:0xf bank_mask:0xa
    v_dot2_f32_bf16 v22, v218, v16, v22
    v_dot2_f32_bf16 v23, v222, v16, v23
    v_add_f32_dpp v10, v10, v10 quad_perm:[1,0,3,2] row_mask:0xf bank_mask:0xf
    v_dot2_f32_bf16 v20, v211, v17, v20
    v_dot2_f32_bf16 v21, v215, v17, v21
    v_add_f32_dpp v10, v10, v10 quad_perm:[2,3,0,1] row_mask:0xf bank_mask:0xf
    v_dot2_f32_bf16 v22, v219, v17, v22
    ds_write_b32 v3, v10 offset:544
    v_dot2_f32_bf16 v23, v223, v17, v23
    v_max_f32 v5, v5, v10
    s_waitcnt vmcnt(4)
    buffer_load_dwordx4 v[76:79], v2, s[8:11], s25 offen offset:2048 nt
    s_addk_i32 s25, 12288
    s_waitcnt vmcnt(20)
    ds_read_b128 v[112:115], v18 offset:4096
    ds_read_b128 v[116:119], v18 offset:5120
    ds_read_b128 v[120:123], v18 offset:6144
    ds_read_b128 v[124:127], v18 offset:7168
    s_waitcnt lgkmcnt(4)
    s_waitcnt vmcnt(24)
    v_dot2_f32_bf16 v6, v96, v14, 0
    v_dot2_f32_bf16 v7, v100, v14, 0
    v_add_f32_dpp v20, v20, v20 row_ror:8 row_mask:0xf bank_mask:0xf
    v_dot2_f32_bf16 v8, v104, v14, 0
    v_add_f32_dpp v21, v21, v21 row_ror:8 row_mask:0xf bank_mask:0xf
    v_dot2_f32_bf16 v9, v108, v14, 0
    v_dot2_f32_bf16 v6, v97, v15, v6
    v_add_f32_dpp v20, v22, v22 row_ror:8 row_mask:0xf bank_mask:0xc
    v_dot2_f32_bf16 v7, v101, v15, v7
    v_add_f32_dpp v21, v23, v23 row_ror:8 row_mask:0xf bank_mask:0xc
    v_dot2_f32_bf16 v8, v105, v15, v8
    v_dot2_f32_bf16 v9, v109, v15, v9
    v_add_f32_dpp v24, v20, v20 row_half_mirror row_mask:0xf bank_mask:0xf
    v_dot2_f32_bf16 v6, v98, v16, v6
    v_dot2_f32_bf16 v7, v102, v16, v7
    v_add_f32_dpp v24, v21, v21 row_half_mirror row_mask:0xf bank_mask:0xa
    v_dot2_f32_bf16 v8, v106, v16, v8
    v_dot2_f32_bf16 v9, v110, v16, v9
    v_add_f32_dpp v24, v24, v24 quad_perm:[1,0,3,2] row_mask:0xf bank_mask:0xf
    v_dot2_f32_bf16 v6, v99, v17, v6
    v_dot2_f32_bf16 v7, v103, v17, v7
    v_add_f32_dpp v24, v24, v24 quad_perm:[2,3,0,1] row_mask:0xf bank_mask:0xf
    v_dot2_f32_bf16 v8, v107, v17, v8
    ds_write_b32 v3, v24 offset:560
    v_dot2_f32_bf16 v9, v111, v17, v9
    v_max_f32 v5, v5, v24
    s_waitcnt vmcnt(4)
    buffer_load_dwordx4 v[80:83], v2, s[8:11], s25 offen nt
    s_waitcnt vmcnt(17)
    ds_read_b128 v[128:131], v18 offset:8192
    ds_read_b128 v[132:135], v18 offset:9216
    ds_read_b128 v[136:139], v18 offset:10240
    ds_read_b128 v[140:143], v18 offset:11264
    s_waitcnt lgkmcnt(4)
    s_waitcnt vmcnt(21)
    v_dot2_f32_bf16 v20, v112, v14, 0
    v_dot2_f32_bf16 v21, v116, v14, 0
    v_add_f32_dpp v6, v6, v6 row_ror:8 row_mask:0xf bank_mask:0xf
    v_dot2_f32_bf16 v22, v120, v14, 0
    v_add_f32_dpp v7, v7, v7 row_ror:8 row_mask:0xf bank_mask:0xf
    v_dot2_f32_bf16 v23, v124, v14, 0
    v_dot2_f32_bf16 v20, v113, v15, v20
    v_add_f32_dpp v6, v8, v8 row_ror:8 row_mask:0xf bank_mask:0xc
    v_dot2_f32_bf16 v21, v117, v15, v21
    v_add_f32_dpp v7, v9, v9 row_ror:8 row_mask:0xf bank_mask:0xc
    v_dot2_f32_bf16 v22, v121, v15, v22
    v_dot2_f32_bf16 v23, v125, v15, v23
    v_add_f32_dpp v10, v6, v6 row_half_mirror row_mask:0xf bank_mask:0xf
    v_dot2_f32_bf16 v20, v114, v16, v20
    v_dot2_f32_bf16 v21, v118, v16, v21
    v_add_f32_dpp v10, v7, v7 row_half_mirror row_mask:0xf bank_mask:0xa
    v_dot2_f32_bf16 v22, v122, v16, v22
    v_dot2_f32_bf16 v23, v126, v16, v23
    v_add_f32_dpp v10, v10, v10 quad_perm:[1,0,3,2] row_mask:0xf bank_mask:0xf
    v_dot2_f32_bf16 v20, v115, v17, v20
    v_dot2_f32_bf16 v21, v119, v17, v21
    v_add_f32_dpp v10, v10, v10 quad_perm:[2,3,0,1] row_mask:0xf bank_mask:0xf
    v_dot2_f32_bf16 v22, v123, v17, v22
    ds_write_b32 v3, v10 offset:768
    v_dot2_f32_bf16 v23, v127, v17, v23
    v_max_f32 v5, v5, v10
    s_waitcnt vmcnt(4)
    buffer_load_dwordx4 v[84:87], v2, s[8:11], s25 offen offset:2048 nt
    s_addk_i32 s25, 4096
    s_waitcnt vmcnt(14)
    ds_read_b128 v[144:147], v18 offset:12288
    ds_read_b128 v[148:151], v18 offset:13312
    ds_read_b128 v[152:155], v18 offset:14336
    ds_read_b128 v[156:159], v18 offset:15360
    s_waitcnt lgkmcnt(4)
    s_waitcnt vmcnt(18)
    v_dot2_f32_bf16 v6, v128, v14, 0
    v_dot2_f32_bf16 v7, v132, v14, 0
    v_add_f32_dpp v20, v20, v20 row_ror:8 row_mask:0xf bank_mask:0xf
    v_dot2_f32_bf16 v8, v136, v14, 0
    v_add_f32_dpp v21, v21, v21 row_ror:8 row_mask:0xf bank_mask:0xf
    v_dot2_f32_bf16 v9, v140, v14, 0
    v_dot2_f32_bf16 v6, v129, v15, v6
    v_add_f32_dpp v20, v22, v22 row_ror:8 row_mask:0xf bank_mask:0xc
    v_dot2_f32_bf16 v7, v133, v15, v7
    v_add_f32_dpp v21, v23, v23 row_ror:8 row_mask:0xf bank_mask:0xc
    v_dot2_f32_bf16 v8, v137, v15, v8
    v_dot2_f32_bf16 v9, v141, v15, v9
    v_add_f32_dpp v24, v20, v20 row_half_mirror row_mask:0xf bank_mask:0xf
    v_dot2_f32_bf16 v6, v130, v16, v6
    v_dot2_f32_bf16 v7, v134, v16, v7
    v_add_f32_dpp v24, v21, v21 row_half_mirror row_mask:0xf bank_mask:0xa
    v_dot2_f32_bf16 v8, v138, v16, v8
    v_dot2_f32_bf16 v9, v142, v16, v9
    v_add_f32_dpp v24, v24, v24 quad_perm:[1,0,3,2] row_mask:0xf bank_mask:0xf
    v_dot2_f32_bf16 v6, v131, v17, v6
    v_dot2_f32_bf16 v7, v135, v17, v7
    v_add_f32_dpp v24, v24, v24 quad_perm:[2,3,0,1] row_mask:0xf bank_mask:0xf
    v_dot2_f32_bf16 v8, v139, v17, v8
    ds_write_b32 v3, v24 offset:784
    v_dot2_f32_bf16 v9, v143, v17, v9
    v_max_f32 v5, v5, v24
    s_waitcnt vmcnt(4)
    buffer_load_dwordx4 v[88:91], v2, s[8:11], s25 offen nt
    s_waitcnt lgkmcnt(0)
    s_barrier
    s_waitcnt vmcnt(15)
    v_dot2_f32_bf16 v20, v144, v14, 0
    v_dot2_f32_bf16 v21, v148, v14, 0
    v_add_f32_dpp v6, v6, v6 row_ror:8 row_mask:0xf bank_mask:0xf
    v_dot2_f32_bf16 v22, v152, v14, 0
    v_add_f32_dpp v7, v7, v7 row_ror:8 row_mask:0xf bank_mask:0xf
    v_dot2_f32_bf16 v23, v156, v14, 0
    v_dot2_f32_bf16 v20, v145, v15, v20
    v_add_f32_dpp v6, v8, v8 row_ror:8 row_mask:0xf bank_mask:0xc
    v_dot2_f32_bf16 v21, v149, v15, v21
    v_add_f32_dpp v7, v9, v9 row_ror:8 row_mask:0xf bank_mask:0xc
    v_dot2_f32_bf16 v22, v153, v15, v22
    v_dot2_f32_bf16 v23, v157, v15, v23
    v_add_f32_dpp v10, v6, v6 row_half_mirror row_mask:0xf bank_mask:0xf
    v_dot2_f32_bf16 v20, v146, v16, v20
    v_dot2_f32_bf16 v21, v150, v16, v21
    v_add_f32_dpp v10, v7, v7 row_half_mirror row_mask:0xf bank_mask:0xa
    v_dot2_f32_bf16 v22, v154, v16, v22
    v_dot2_f32_bf16 v23, v158, v16, v23
    v_add_f32_dpp v10, v10, v10 quad_perm:[1,0,3,2] row_mask:0xf bank_mask:0xf
    v_dot2_f32_bf16 v20, v147, v17, v20
    v_dot2_f32_bf16 v21, v151, v17, v21
    v_add_f32_dpp v10, v10, v10 quad_perm:[2,3,0,1] row_mask:0xf bank_mask:0xf
    v_dot2_f32_bf16 v22, v155, v17, v22
    ds_write_b32 v3, v10 offset:800
    v_dot2_f32_bf16 v23, v159, v17, v23
    v_max_f32 v5, v5, v10
    s_waitcnt vmcnt(4)
    buffer_load_dwordx4 v[92:95], v2, s[8:11], s25 offen offset:2048 nt
    s_add_u32 s25, s25, 45056
    s_and_b32 s25, s25, 2097151
    s_waitcnt vmcnt(12)
    v_dot2_f32_bf16 v6, v32, v14, 0
    v_dot2_f32_bf16 v7, v36, v14, 0
    v_add_f32_dpp v20, v20, v20 row_ror:8 row_mask:0xf bank_mask:0xf
    v_dot2_f32_bf16 v8, v40, v14, 0
    v_add_f32_dpp v21, v21, v21 row_ror:8 row_mask:0xf bank_mask:0xf
    v_dot2_f32_bf16 v9, v44, v14, 0
    v_dot2_f32_bf16 v6, v33, v15, v6
    v_add_f32_dpp v20, v22, v22 row_ror:8 row_mask:0xf bank_mask:0xc
    v_dot2_f32_bf16 v7, v37, v15, v7
    v_add_f32_dpp v21, v23, v23 row_ror:8 row_mask:0xf bank_mask:0xc
    v_dot2_f32_bf16 v8, v41, v15, v8
    v_dot2_f32_bf16 v9, v45, v15, v9
    v_add_f32_dpp v24, v20, v20 row_half_mirror row_mask:0xf bank_mask:0xf
    v_dot2_f32_bf16 v6, v34, v16, v6
    v_dot2_f32_bf16 v7, v38, v16, v7
    v_add_f32_dpp v24, v21, v21 row_half_mirror row_mask:0xf bank_mask:0xa
    v_dot2_f32_bf16 v8, v42, v16, v8
    v_dot2_f32_bf16 v9, v46, v16, v9
    v_add_f32_dpp v24, v24, v24 quad_perm:[1,0,3,2] row_mask:0xf bank_mask:0xf
    v_dot2_f32_bf16 v6, v35, v17, v6
    v_dot2_f32_bf16 v7, v39, v17, v7
    v_add_f32_dpp v24, v24, v24 quad_perm:[2,3,0,1] row_mask:0xf bank_mask:0xf
    v_dot2_f32_bf16 v8, v43, v17, v8
    ds_write_b32 v3, v24 offset:816
    v_dot2_f32_bf16 v9, v47, v17, v9
    v_max_f32 v5, v5, v24
    s_waitcnt vmcnt(4)
    buffer_load_dwordx4 v[32:35], v2, s[8:11], s25 offen nt
    s_waitcnt vmcnt(9)
    v_dot2_f32_bf16 v20, v48, v14, 0
    v_dot2_f32_bf16 v21, v52, v14, 0
    v_add_f32_dpp v6, v6, v6 row_ror:8 row_mask:0xf bank_mask:0xf
    v_dot2_f32_bf16 v22, v56, v14, 0
    v_add_f32_dpp v7, v7, v7 row_ror:8 row_mask:0xf bank_mask:0xf
    v_dot2_f32_bf16 v23, v60, v14, 0
    v_dot2_f32_bf16 v20, v49, v15, v20
    v_add_f32_dpp v6, v8, v8 row_ror:8 row_mask:0xf bank_mask:0xc
    v_dot2_f32_bf16 v21, v53, v15, v21
    v_add_f32_dpp v7, v9, v9 row_ror:8 row_mask:0xf bank_mask:0xc
    v_dot2_f32_bf16 v22, v57, v15, v22
    v_dot2_f32_bf16 v23, v61, v15, v23
    v_add_f32_dpp v10, v6, v6 row_half_mirror row_mask:0xf bank_mask:0xf
    v_dot2_f32_bf16 v20, v50, v16, v20
    v_dot2_f32_bf16 v21, v54, v16, v21
    v_add_f32_dpp v10, v7, v7 row_half_mirror row_mask:0xf bank_mask:0xa
    v_dot2_f32_bf16 v22, v58, v16, v22
    v_dot2_f32_bf16 v23, v62, v16, v23
    v_add_f32_dpp v10, v10, v10 quad_perm:[1,0,3,2] row_mask:0xf bank_mask:0xf
    v_dot2_f32_bf16 v20, v51, v17, v20
    v_dot2_f32_bf16 v21, v55, v17, v21
    v_add_f32_dpp v10, v10, v10 quad_perm:[2,3,0,1] row_mask:0xf bank_mask:0xf
    v_dot2_f32_bf16 v22, v59, v17, v22
    ds_write_b32 v3, v10 offset:1024
    v_dot2_f32_bf16 v23, v63, v17, v23
    v_max_f32 v5, v5, v10
    s_waitcnt vmcnt(4)
    buffer_load_dwordx4 v[36:39], v2, s[8:11], s25 offen offset:2048 nt
    s_addk_i32 s25, 4096
    v_add_f32_dpp v20, v20, v20 row_ror:8 row_mask:0xf bank_mask:0xf
    v_add_f32_dpp v21, v21, v21 row_ror:8 row_mask:0xf bank_mask:0xf
    s_nop 0
    v_add_f32_dpp v20, v22, v22 row_ror:8 row_mask:0xf bank_mask:0xc
    v_add_f32_dpp v21, v23, v23 row_ror:8 row_mask:0xf bank_mask:0xc
    s_nop 0
    v_add_f32_dpp v24, v20, v20 row_half_mirror row_mask:0xf bank_mask:0xf
    s_nop 1
    v_add_f32_dpp v24, v21, v21 row_half_mirror row_mask:0xf bank_mask:0xa
    s_nop 1
    v_add_f32_dpp v24, v24, v24 quad_perm:[1,0,3,2] row_mask:0xf bank_mask:0xf
    s_nop 1
    v_add_f32_dpp v24, v24, v24 quad_perm:[2,3,0,1] row_mask:0xf bank_mask:0xf
    ds_write_b32 v3, v24 offset:1040
    v_max_f32 v5, v5, v24
    s_waitcnt vmcnt(9)
    v_dot2_f32_bf16 v6, v64, v14, 0
    v_dot2_f32_bf16 v6, v65, v15, v6
    v_dot2_f32_bf16 v6, v66, v16, v6
    v_dot2_f32_bf16 v6, v67, v17, v6
    s_mul_i32 s31, s23, -65536
    s_add_u32 s31, s31, 32768
    v_and_b32 v12, 1, v1
    v_lshlrev_b32 v12, 4, v12
    v_mov_b32 v13, 0xffff
    v_lshlrev_b32 v13, v12, v13
    v_bfe_u32 v12, v1, 1, 2
    s_waitcnt vmcnt(8)
    v_dot2_f32_bf16 v7, v68, v14, 0
    v_dot2_f32_bf16 v7, v69, v15, v7
    v_dot2_f32_bf16 v7, v70, v16, v7
    v_dot2_f32_bf16 v7, v71, v17, v7
    v_cmp_eq_u32 vcc, 0, v12
    s_nop 1
    v_cndmask_b32 v18, 0, v13, vcc
    v_cmp_eq_u32 vcc, 1, v12
    s_nop 1
    v_cndmask_b32 v19, 0, v13, vcc
    v_cmp_eq_u32 vcc, 2, v12
    s_nop 1
    v_cndmask_b32 v20, 0, v13, vcc
    v_cmp_eq_u32 vcc, 3, v12
    s_nop 1
    v_cndmask_b32 v21, 0, v13, vcc
    v_mov_b32 v28, 0
    s_waitcnt vmcnt(7)
    v_dot2_f32_bf16 v8, v72, v14, 0
    v_dot2_f32_bf16 v8, v73, v15, v8
    v_dot2_f32_bf16 v8, v74, v16, v8
    v_dot2_f32_bf16 v8, v75, v17, v8
    v_mov_b32 v29, 0
    v_mov_b32 v30, 0
    v_mov_b32 v31, 0
    v_mov_b32 v11, 19712
    v_lshl_add_u32 v11, s20, 2, v11
    v_mov_b32 v12, 10
    v_mov_b32 v105, 0
    v_and_b32 v100, 15, v1
    v_lshlrev_b32 v100, 4, v100
    s_waitcnt vmcnt(4)
    buffer_load_dwordx4 v[40:43], v2, s[8:11], s25 offen nt
    s_waitcnt vmcnt(7)
    v_dot2_f32_bf16 v9, v76, v14, 0
    v_dot2_f32_bf16 v9, v77, v15, v9
    v_dot2_f32_bf16 v9, v78, v16, v9
    v_dot2_f32_bf16 v9, v79, v17, v9
    v_add_f32_dpp v6, v6, v6 row_ror:8 row_mask:0xf bank_mask:0xf
    v_add_f32_dpp v7, v7, v7 row_ror:8 row_mask:0xf bank_mask:0xf
    s_nop 0
    v_add_f32_dpp v6, v8, v8 row_ror:8 row_mask:0xf bank_mask:0xc
    v_add_f32_dpp v7, v9, v9 row_ror:8 row_mask:0xf bank_mask:0xc
    s_nop 0
    v_add_f32_dpp v10, v6, v6 row_half_mirror row_mask:0xf bank_mask:0xf
    s_nop 1
    v_add_f32_dpp v10, v7, v7 row_half_mirror row_mask:0xf bank_mask:0xa
    s_nop 1
    v_add_f32_dpp v10, v10, v10 quad_perm:[1,0,3,2] row_mask:0xf bank_mask:0xf
    s_nop 1
    v_add_f32_dpp v10, v10, v10 quad_perm:[2,3,0,1] row_mask:0xf bank_mask:0xf
    ds_write_b32 v3, v10 offset:1056
    v_max_f32 v5, v5, v10
    s_waitcnt vmcnt(4)
    buffer_load_dwordx4 v[44:47], v2, s[8:11], s25 offen offset:2048 nt
    s_addk_i32 s25, 12288
    s_waitcnt vmcnt(7)
    v_dot2_f32_bf16 v6, v80, v14, 0
    v_dot2_f32_bf16 v6, v81, v15, v6
    v_dot2_f32_bf16 v6, v82, v16, v6
    v_dot2_f32_bf16 v6, v83, v17, v6
    v_bfe_u32 v101, v1, 4, 1
    v_lshl_add_u32 v100, v101, 3, v100
    s_mul_i32 s16, s20, 320
    v_add_u32 v100, s16, v100
    s_and_b32 s17, s2, 15
    s_lshl_b32 s19, s17, 6
    s_lshl_b32 s18, s21, 10
    s_add_u32 s19, s19, s18
    s_lshl_b32 s16, s21, 16
    s_waitcnt vmcnt(4)
    buffer_load_dwordx4 v[48:51], v2, s[8:11], s25 offen nt
    s_waitcnt vmcnt(7)
    v_dot2_f32_bf16 v7, v84, v14, 0
    v_dot2_f32_bf16 v7, v85, v15, v7
    v_dot2_f32_bf16 v7, v86, v16, v7
    v_dot2_f32_bf16 v7, v87, v17, v7
    s_and_b32 s17, s2, 15
    s_lshl_b32 s17, s17, 12
    s_add_u32 s16, s16, s17
    v_lshl_add_u32 v101, v1, 4, s16
    v_and_b32 v103, 31, v1
    v_lshl_add_u32 v102, v103, 1, s19
    v_lshlrev_b32 v104, 4, v103
    v_lshlrev_b32 v103, 3, v103
    v_and_b32 v148, 0x3f803f80, v18
    s_waitcnt vmcnt(4)
    buffer_load_dwordx4 v[52:55], v2, s[8:11], s25 offen offset:2048 nt
    s_addk_i32 s25, 4096
    s_waitcnt vmcnt(7)
    v_dot2_f32_bf16 v8, v88, v14, 0
    v_dot2_f32_bf16 v8, v89, v15, v8
    v_dot2_f32_bf16 v8, v90, v16, v8
    v_dot2_f32_bf16 v8, v91, v17, v8
    v_and_b32 v149, 0x3f803f80, v19
    v_and_b32 v150, 0x3f803f80, v20
    v_and_b32 v151, 0x3f803f80, v21
    s_bfe_u32 s23, s2, 0x20004
    s_mov_b32 s18, 0x3db504f3
    s_mov_b32 s19, 0x3fb8aa3b
    s_waitcnt vmcnt(4)
    buffer_load_dwordx4 v[56:59], v2, s[8:11], s25 offen nt
    s_waitcnt vmcnt(7)
    v_dot2_f32_bf16 v9, v92, v14, 0
    v_dot2_f32_bf16 v9, v93, v15, v9
    v_dot2_f32_bf16 v9, v94, v16, v9
    v_dot2_f32_bf16 v9, v95, v17, v9
    v_add_f32_dpp v6, v6, v6 row_ror:8 row_mask:0xf bank_mask:0xf
    v_add_f32_dpp v7, v7, v7 row_ror:8 row_mask:0xf bank_mask:0xf
    s_nop 0
    v_add_f32_dpp v6, v8, v8 row_ror:8 row_mask:0xf bank_mask:0xc
    v_add_f32_dpp v7, v9, v9 row_ror:8 row_mask:0xf bank_mask:0xc
    s_nop 0
    v_add_f32_dpp v10, v6, v6 row_half_mirror row_mask:0xf bank_mask:0xf
    s_nop 1
    v_add_f32_dpp v10, v7, v7 row_half_mirror row_mask:0xf bank_mask:0xa
    s_nop 1
    v_add_f32_dpp v10, v10, v10 quad_perm:[1,0,3,2] row_mask:0xf bank_mask:0xf
    s_nop 1
    v_add_f32_dpp v10, v10, v10 quad_perm:[2,3,0,1] row_mask:0xf bank_mask:0xf
    ds_write_b32 v3, v10 offset:1072
    v_max_f32 v5, v5, v10
    v_add_u32 v3, 1280, v3
    s_mov_b32 s26, 5
    s_mov_b64 vcc, 0
    s_mov_b64 s[58:59], 0
L_kloop:
    s_waitcnt vmcnt(6)
    s_cbranch_vccnz L_w1
    s_waitcnt vmcnt(4)
L_w1:
    buffer_load_dwordx4 v[60:63], v2, s[8:11], s25 offen offset:2048 nt
    s_add_u32 s25, s25, 45056
    v_dot2_f32_bf16 v6, v32, v14, 0
    v_dot2_f32_bf16 v6, v33, v15, v6
    v_dot2_f32_bf16 v6, v34, v16, v6
    v_dot2_f32_bf16 v6, v35, v17, v6
    ds_read_b32 v96, v105 offset:19744
    ds_write_b32 v11, v12
    v_add_u32 v12, 1, v12
    s_waitcnt vmcnt(6)
    s_cbranch_vccnz L_w2
    s_waitcnt vmcnt(4)
L_w2:
    buffer_load_dwordx4 v[64:67], v2, s[8:11], s25 offen nt
    v_dot2_f32_bf16 v7, v36, v14, 0
    v_dot2_f32_bf16 v7, v37, v15, v7
    v_dot2_f32_bf16 v7, v38, v16, v7
    v_dot2_f32_bf16 v7, v39, v17, v7
    s_waitcnt lgkmcnt(0)
    v_cmp_ge_u32 vcc, v96, v12
    s_waitcnt vmcnt(6)
    s_nop 0
    s_cbranch_vccnz L_w3
    s_waitcnt vmcnt(4)
L_w3:
    buffer_load_dwordx4 v[68:71], v2, s[8:11], s25 offen offset:2048 nt
    s_addk_i32 s25, 4096
    v_dot2_f32_bf16 v8, v40, v14, 0
    v_dot2_f32_bf16 v8, v41, v15, v8
    v_dot2_f32_bf16 v8, v42, v16, v8
    v_dot2_f32_bf16 v8, v43, v17, v8
    s_waitcnt vmcnt(6)
    s_cbranch_vccnz L_w4
    s_waitcnt vmcnt(4)
L_w4:
    buffer_load_dwordx4 v[72:75], v2, s[8:11], s25 offen nt
    v_dot2_f32_bf16 v9, v44, v14, 0
    v_dot2_f32_bf16 v9, v45, v15, v9
    v_dot2_f32_bf16 v9, v46, v16, v9
    v_dot2_f32_bf16 v9, v47, v17, v9
    v_add_f32_dpp v6, v6, v6 row_ror:8 row_mask:0xf bank_mask:0xf
    v_add_f32_dpp v7, v7, v7 row_ror:8 row_mask:0xf bank_mask:0xf
    s_nop 0
    v_add_f32_dpp v6, v8, v8 row_ror:8 row_mask:0xf bank_mask:0xc
    v_add_f32_dpp v7, v9, v9 row_ror:8 row_mask:0xf bank_mask:0xc
    s_nop 0
    v_add_f32_dpp v10, v6, v6 row_half_mirror row_mask:0xf bank_mask:0xf
    s_nop 1
    v_add_f32_dpp v10, v7, v7 row_half_mirror row_mask:0xf bank_mask:0xa
    s_nop 1
    v_add_f32_dpp v10, v10, v10 quad_perm:[1,0,3,2] row_mask:0xf bank_mask:0xf
    s_nop 1
    v_add_f32_dpp v10, v10, v10 quad_perm:[2,3,0,1] row_mask:0xf bank_mask:0xf
    ds_write_b32 v3, v10 offset:0
    v_max_f32 v5, v5, v10
    s_waitcnt vmcnt(6)
    s_cbranch_vccnz L_w5
    s_waitcnt vmcnt(4)
L_w5:
    buffer_load_dwordx4 v[76:79], v2, s[8:11], s25 offen offset:2048 nt
    s_addk_i32 s25, 12288
    v_dot2_f32_bf16 v6, v48, v14, 0
    v_dot2_f32_bf16 v6, v49, v15, v6
    v_dot2_f32_bf16 v6, v50, v16, v6
    v_dot2_f32_bf16 v6, v51, v17, v6
    s_waitcnt vmcnt(6)
    s_cbranch_vccnz L_w6
    s_waitcnt vmcnt(4)
L_w6:
    buffer_load_dwordx4 v[80:83], v2, s[8:11], s25 offen nt
    v_dot2_f32_bf16 v7, v52, v14, 0
    v_dot2_f32_bf16 v7, v53, v15, v7
    v_dot2_f32_bf16 v7, v54, v16, v7
    v_dot2_f32_bf16 v7, v55, v17, v7
    s_waitcnt vmcnt(6)
    s_cbranch_vccnz L_w7
    s_waitcnt vmcnt(4)
L_w7:
    buffer_load_dwordx4 v[84:87], v2, s[8:11], s25 offen offset:2048 nt
    s_addk_i32 s25, 4096
    v_dot2_f32_bf16 v8, v56, v14, 0
    v_dot2_f32_bf16 v8, v57, v15, v8
    v_dot2_f32_bf16 v8, v58, v16, v8
    v_dot2_f32_bf16 v8, v59, v17, v8
    s_waitcnt vmcnt(6)
    s_cbranch_vccnz L_w8
    s_waitcnt vmcnt(4)
L_w8:
    buffer_load_dwordx4 v[88:91], v2, s[8:11], s25 offen nt
    v_dot2_f32_bf16 v9, v60, v14, 0
    v_dot2_f32_bf16 v9, v61, v15, v9
    v_dot2_f32_bf16 v9, v62, v16, v9
    v_dot2_f32_bf16 v9, v63, v17, v9
    v_add_f32_dpp v6, v6, v6 row_ror:8 row_mask:0xf bank_mask:0xf
    v_add_f32_dpp v7, v7, v7 row_ror:8 row_mask:0xf bank_mask:0xf
    s_nop 0
    v_add_f32_dpp v6, v8, v8 row_ror:8 row_mask:0xf bank_mask:0xc
    v_add_f32_dpp v7, v9, v9 row_ror:8 row_mask:0xf bank_mask:0xc
    s_nop 0
    v_add_f32_dpp v10, v6, v6 row_half_mirror row_mask:0xf bank_mask:0xf
    s_nop 1
    v_add_f32_dpp v10, v7, v7 row_half_mirror row_mask:0xf bank_mask:0xa
    s_nop 1
    v_add_f32_dpp v10, v10, v10 quad_perm:[1,0,3,2] row_mask:0xf bank_mask:0xf
    s_nop 1
    v_add_f32_dpp v10, v10, v10 quad_perm:[2,3,0,1] row_mask:0xf bank_mask:0xf
    ds_write_b32 v3, v10 offset:16
    v_max_f32 v5, v5, v10
    s_waitcnt vmcnt(6)
    s_cbranch_vccnz L_w9
    s_waitcnt vmcnt(4)
L_w9:
    buffer_load_dwordx4 v[92:95], v2, s[8:11], s25 offen offset:2048 nt
    s_add_u32 s25, s25, 45056
    s_and_b32 s25, s25, 2097151
    v_dot2_f32_bf16 v6, v64, v14, 0
    v_dot2_f32_bf16 v6, v65, v15, v6
    v_dot2_f32_bf16 v6, v66, v16, v6
    v_dot2_f32_bf16 v6, v67, v17, v6
    ds_read_b32 v96, v105 offset:19744
    ds_write_b32 v11, v12
    v_add_u32 v12, 1, v12
    s_cmp_eq_u32 s26, 15
    s_cselect_b32 s8, s12, s8
    s_cselect_b32 s9, s13, s9
    s_waitcnt vmcnt(6)
    s_cbranch_vccnz L_w10
    s_waitcnt vmcnt(4)
L_w10:
    buffer_load_dwordx4 v[32:35], v2, s[8:11], s25 offen nt
    v_dot2_f32_bf16 v7, v68, v14, 0
    v_dot2_f32_bf16 v7, v69, v15, v7
    v_dot2_f32_bf16 v7, v70, v16, v7
    v_dot2_f32_bf16 v7, v71, v17, v7
    s_waitcnt lgkmcnt(0)
    v_cmp_ge_u32 vcc, v96, v12
    s_waitcnt vmcnt(6)
    s_nop 0
    s_cbranch_vccnz L_w11
    s_waitcnt vmcnt(4)
L_w11:
    buffer_load_dwordx4 v[36:39], v2, s[8:11], s25 offen offset:2048 nt
    s_addk_i32 s25, 4096
    v_dot2_f32_bf16 v8, v72, v14, 0
    v_dot2_f32_bf16 v8, v73, v15, v8
    v_dot2_f32_bf16 v8, v74, v16, v8
    v_dot2_f32_bf16 v8, v75, v17, v8
    s_waitcnt vmcnt(6)
    s_cbranch_vccnz L_w12
    s_waitcnt vmcnt(4)
L_w12:
    buffer_load_dwordx4 v[40:43], v2, s[8:11], s25 offen nt
    v_dot2_f32_bf16 v9, v76, v14, 0
    v_dot2_f32_bf16 v9, v77, v15, v9
    v_dot2_f32_bf16 v9, v78, v16, v9
    v_dot2_f32_bf16 v9, v79, v17, v9
    v_add_f32_dpp v6, v6, v6 row_ror:8 row_mask:0xf bank_mask:0xf
    v_add_f32_dpp v7, v7, v7 row_ror:8 row_mask:0xf bank_mask:0xf
    s_nop 0
    v_add_f32_dpp v6, v8, v8 row_ror:8 row_mask:0xf bank_mask:0xc
    v_add_f32_dpp v7, v9, v9 row_ror:8 row_mask:0xf bank_mask:0xc
    s_nop 0
    v_add_f32_dpp v10, v6, v6 row_half_mirror row_mask:0xf bank_mask:0xf
    s_nop 1
    v_add_f32_dpp v10, v7, v7 row_half_mirror row_mask:0xf bank_mask:0xa
    s_nop 1
    v_add_f32_dpp v10, v10, v10 quad_perm:[1,0,3,2] row_mask:0xf bank_mask:0xf
    s_nop 1
    v_add_f32_dpp v10, v10, v10 quad_perm:[2,3,0,1] row_mask:0xf bank_mask:0xf
    ds_write_b32 v3, v10 offset:32
    v_max_f32 v5, v5, v10
    s_waitcnt vmcnt(6)
    s_cbranch_vccnz L_w13
    s_waitcnt vmcnt(4)
L_w13:
    buffer_load_dwordx4 v[44:47], v2, s[8:11], s25 offen offset:2048 nt
    s_addk_i32 s25, 12288
    v_dot2_f32_bf16 v6, v80, v14, 0
    v_dot2_f32_bf16 v6, v81, v15, v6
    v_dot2_f32_bf16 v6, v82, v16, v6
    v_dot2_f32_bf16 v6, v83, v17, v6
    s_waitcnt vmcnt(6)
    s_cbranch_vccnz L_w14
    s_waitcnt vmcnt(4)
L_w14:
    buffer_load_dwordx4 v[48:51], v2, s[8:11], s25 offen nt
    v_dot2_f32_bf16 v7, v84, v14, 0
    v_dot2_f32_bf16 v7, v85, v15, v7
    v_dot2_f32_bf16 v7, v86, v16, v7
    v_dot2_f32_bf16 v7, v87, v17, v7
    s_waitcnt vmcnt(6)
    s_cbranch_vccnz L_w15
    s_waitcnt vmcnt(4)
L_w15:
    buffer_load_dwordx4 v[52:55], v2, s[8:11], s25 offen offset:2048 nt
    s_addk_i32 s25, 4096
    v_dot2_f32_bf16 v8, v88, v14, 0
    v_dot2_f32_bf16 v8, v89, v15, v8
    v_dot2_f32_bf16 v8, v90, v16, v8
    v_dot2_f32_bf16 v8, v91, v17, v8
    s_waitcnt vmcnt(6)
    s_cbranch_vccnz L_w16
    s_waitcnt vmcnt(4)
L_w16:
    buffer_load_dwordx4 v[56:59], v2, s[8:11], s25 offen nt
    v_dot2_f32_bf16 v9, v92, v14, 0
    v_dot2_f32_bf16 v9, v93, v15, v9
    v_dot2_f32_bf16 v9, v94, v16, v9
    v_dot2_f32_bf16 v9, v95, v17, v9
    v_add_f32_dpp v6, v6, v6 row_ror:8 row_mask:0xf bank_mask:0xf
    v_add_f32_dpp v7, v7, v7 row_ror:8 row_mask:0xf bank_mask:0xf
    s_nop 0
    v_add_f32_dpp v6, v8, v8 row_ror:8 row_mask:0xf bank_mask:0xc
    v_add_f32_dpp v7, v9, v9 row_ror:8 row_mask:0xf bank_mask:0xc
    s_nop 0
    v_add_f32_dpp v10, v6, v6 row_half_mirror row_mask:0xf bank_mask:0xf
    s_nop 1
    v_add_f32_dpp v10, v7, v7 row_half_mirror row_mask:0xf bank_mask:0xa
    s_nop 1
    v_add_f32_dpp v10, v10, v10 quad_perm:[1,0,3,2] row_mask:0xf bank_mask:0xf
    s_nop 1
    v_add_f32_dpp v10, v10, v10 quad_perm:[2,3,0,1] row_mask:0xf bank_mask:0xf
    ds_write_b32 v3, v10 offset:48
    v_max_f32 v5, v5, v10
    v_add_u32 v3, 256, v3
    s_add_u32 s26, s26, 1
    s_cmp_lt_u32 s26, 16
    s_cbranch_scc1 L_kloop
    ds_read_b32 v22, v4
    v_max_f32_dpp v5, v5, v5 quad_perm:[1,0,3,2] row_mask:0xf bank_mask:0xf
    s_nop 1
    v_max_f32_dpp v5, v5, v5 quad_perm:[2,3,0,1] row_mask:0xf bank_mask:0xf
    s_nop 1
    v_max_f32_dpp v5, v5, v5 row_half_mirror row_mask:0xf bank_mask:0xf
    s_nop 1
    v_max_f32_dpp v5, v5, v5 row_mirror row_mask:0xf bank_mask:0xf
    s_nop 1
    v_max_f32_dpp v5, v5, v5 row_bcast:15 row_mask:0xa bank_mask:0xf
    s_nop 1
    v_max_f32_dpp v5, v5, v5 row_bcast:31 row_mask:0xc bank_mask:0xf
    s_nop 0
    v_readlane_b32 s17, v5, 63
    s_nop 1
    v_cvt_pk_bf16_f32 v5, 0, s17
    v_mul_f32 v5, s18, v5
    v_cvt_pk_bf16_f32 v5, 0, v5
    v_mul_f32 v5, s19, v5
    s_waitcnt lgkmcnt(0)
    v_cvt_pk_bf16_f32 v22, 0, v22
    v_mul_f32 v22, s18, v22
    v_cvt_pk_bf16_f32 v22, 0, v22
    v_fma_f32 v22, v22, s19, -v5
    v_exp_f32 v22, v22
    s_nop 0
    v_cvt_pk_bf16_f32 v22, v22, v22
    s_nop 1
    v_and_b32_dpp v24, v22, v18 row_newbcast:0 row_mask:0xf bank_mask:0xf
    v_and_b32_dpp v25, v22, v19 row_newbcast:0 row_mask:0xf bank_mask:0xf
    v_and_b32_dpp v26, v22, v20 row_newbcast:0 row_mask:0xf bank_mask:0xf
    v_and_b32_dpp v27, v22, v21 row_newbcast:0 row_mask:0xf bank_mask:0xf
    s_mov_b32 s26, 0
L_vloop:
    s_waitcnt vmcnt(6)
    s_cbranch_vccnz L_w17
    s_waitcnt vmcnt(4)
L_w17:
    buffer_load_dwordx4 v[60:63], v2, s[8:11], s25 offen offset:2048 nt
    s_add_u32 s25, s25, 45056
    v_mfma_f32_16x16x32_bf16 v[28:31], v[24:27], v[32:35], v[28:31]
    v_and_b32_dpp v24, v22, v18 row_newbcast:1 row_mask:0xf bank_mask:0xf
    v_and_b32_dpp v25, v22, v19 row_newbcast:1 row_mask:0xf bank_mask:0xf
    v_and_b32_dpp v26, v22, v20 row_newbcast:1 row_mask:0xf bank_mask:0xf
    v_and_b32_dpp v27, v22, v21 row_newbcast:1 row_mask:0xf bank_mask:0xf
    ds_read_b32 v23, v4 offset:256
    v_add_u32 v4, 256, v4
    ds_read_b32 v96, v105 offset:19744
    ds_write_b32 v11, v12
    v_add_u32 v12, 1, v12
    s_waitcnt vmcnt(6)
    s_cbranch_vccnz L_w18
    s_waitcnt vmcnt(4)
L_w18:
    buffer_load_dwordx4 v[64:67], v2, s[8:11], s25 offen nt
    v_mfma_f32_16x16x32_bf16 v[28:31], v[24:27], v[36:39], v[28:31]
    v_and_b32_dpp v24, v22, v18 row_newbcast:2 row_mask:0xf bank_mask:0xf
    v_and_b32_dpp v25, v22, v19 row_newbcast:2 row_mask:0xf bank_mask:0xf
    v_and_b32_dpp v26, v22, v20 row_newbcast:2 row_mask:0xf bank_mask:0xf
    v_and_b32_dpp v27, v22, v21 row_newbcast:2 row_mask:0xf bank_mask:0xf
    s_waitcnt lgkmcnt(0)
    v_cvt_pk_bf16_f32 v23, 0, v23
    v_mul_f32 v23, s18, v23
    v_cvt_pk_bf16_f32 v23, 0, v23
    v_fma_f32 v23, v23, s19, -v5
    v_exp_f32 v23, v23
    s_nop 0
    v_cvt_pk_bf16_f32 v23, v23, v23
    v_cmp_ge_u32 vcc, v96, v12
    s_cmp_ge_u32 s26, 16
    s_nop 0
    s_cselect_b64 vcc, -1, vcc
    s_waitcnt vmcnt(6)
    s_cbranch_vccnz L_w19
    s_waitcnt vmcnt(4)
L_w19:
    buffer_load_dwordx4 v[68:71], v2, s[8:11], s25 offen offset:2048 nt
    s_addk_i32 s25, 4096
    v_mfma_f32_16x16x32_bf16 v[28:31], v[24:27], v[40:43], v[28:31]
    v_and_b32_dpp v24, v22, v18 row_newbcast:3 row_mask:0xf bank_mask:0xf
    v_and_b32_dpp v25, v22, v19 row_newbcast:3 row_mask:0xf bank_mask:0xf
    v_and_b32_dpp v26, v22, v20 row_newbcast:3 row_mask:0xf bank_mask:0xf
    v_and_b32_dpp v27, v22, v21 row_newbcast:3 row_mask:0xf bank_mask:0xf
    s_waitcnt vmcnt(6)
    s_cbranch_vccnz L_w20
    s_waitcnt vmcnt(4)
L_w20:
    buffer_load_dwordx4 v[72:75], v2, s[8:11], s25 offen nt
    v_mfma_f32_16x16x32_bf16 v[28:31], v[24:27], v[44:47], v[28:31]
    v_and_b32_dpp v24, v22, v18 row_newbcast:4 row_mask:0xf bank_mask:0xf
    v_and_b32_dpp v25, v22, v19 row_newbcast:4 row_mask:0xf bank_mask:0xf
    v_and_b32_dpp v26, v22, v20 row_newbcast:4 row_mask:0xf bank_mask:0xf
    v_and_b32_dpp v27, v22, v21 row_newbcast:4 row_mask:0xf bank_mask:0xf
    s_waitcnt vmcnt(6)
    s_cbranch_vccnz L_w21
    s_waitcnt vmcnt(4)
L_w21:
    buffer_load_dwordx4 v[76:79], v2, s[8:11], s25 offen offset:2048 nt
    s_addk_i32 s25, 12288
    v_mfma_f32_16x16x32_bf16 v[28:31], v[24:27], v[48:51], v[28:31]
    v_and_b32_dpp v24, v22, v18 row_newbcast:5 row_mask:0xf bank_mask:0xf
    v_and_b32_dpp v25, v22, v19 row_newbcast:5 row_mask:0xf bank_mask:0xf
    v_and_b32_dpp v26, v22, v20 row_newbcast:5 row_mask:0xf bank_mask:0xf
    v_and_b32_dpp v27, v22, v21 row_newbcast:5 row_mask:0xf bank_mask:0xf
    s_waitcnt vmcnt(6)
    s_cbranch_vccnz L_w22
    s_waitcnt vmcnt(4)
L_w22:
    buffer_load_dwordx4 v[80:83], v2, s[8:11], s25 offen nt
    v_mfma_f32_16x16x32_bf16 v[28:31], v[24:27], v[52:55], v[28:31]
    v_and_b32_dpp v24, v22, v18 row_newbcast:6 row_mask:0xf bank_mask:0xf
    v_and_b32_dpp v25, v22, v19 row_newbcast:6 row_mask:0xf bank_mask:0xf
    v_and_b32_dpp v26, v22, v20 row_newbcast:6 row_mask:0xf bank_mask:0xf
    v_and_b32_dpp v27, v22, v21 row_newbcast:6 row_mask:0xf bank_mask:0xf
    s_waitcnt vmcnt(6)
    s_cbranch_vccnz L_w23
    s_waitcnt vmcnt(4)
L_w23:
    buffer_load_dwordx4 v[84:87], v2, s[8:11], s25 offen offset:2048 nt
    s_addk_i32 s25, 4096
    v_mfma_f32_16x16x32_bf16 v[28:31], v[24:27], v[56:59], v[28:31]
    v_and_b32_dpp v24, v22, v18 row_newbcast:7 row_mask:0xf bank_mask:0xf
    v_and_b32_dpp v25, v22, v19 row_newbcast:7 row_mask:0xf bank_mask:0xf
    v_and_b32_dpp v26, v22, v20 row_newbcast:7 row_mask:0xf bank_mask:0xf
    v_and_b32_dpp v27, v22, v21 row_newbcast:7 row_mask:0xf bank_mask:0xf
    s_waitcnt vmcnt(6)
    s_cbranch_vccnz L_w24
    s_waitcnt vmcnt(4)
L_w24:
    buffer_load_dwordx4 v[88:91], v2, s[8:11], s25 offen nt
    v_mfma_f32_16x16x32_bf16 v[28:31], v[24:27], v[60:63], v[28:31]
    v_and_b32_dpp v24, v22, v18 row_newbcast:8 row_mask:0xf bank_mask:0xf
    v_and_b32_dpp v25, v22, v19 row_newbcast:8 row_mask:0xf bank_mask:0xf
    v_and_b32_dpp v26, v22, v20 row_newbcast:8 row_mask:0xf bank_mask:0xf
    v_and_b32_dpp v27, v22, v21 row_newbcast:8 row_mask:0xf bank_mask:0xf
    s_waitcnt vmcnt(6)
    s_cbranch_vccnz L_w25
    s_waitcnt vmcnt(4)
L_w25:
    buffer_load_dwordx4 v[92:95], v2, s[8:11], s25 offen offset:2048 nt
    s_add_u32 s25, s25, 45056
    s_and_b32 s25, s25, 2097151
    v_mfma_f32_16x16x32_bf16 v[28:31], v[24:27], v[64:67], v[28:31]
    v_and_b32_dpp v24, v22, v18 row_newbcast:9 row_mask:0xf bank_mask:0xf
    v_and_b32_dpp v25, v22, v19 row_newbcast:9 row_mask:0xf bank_mask:0xf
    v_and_b32_dpp v26, v22, v20 row_newbcast:9 row_mask:0xf bank_mask:0xf
    v_and_b32_dpp v27, v22, v21 row_newbcast:9 row_mask:0xf bank_mask:0xf
    ds_read_b32 v96, v105 offset:19744
    ds_write_b32 v11, v12
    v_add_u32 v12, 1, v12
    s_add_u32 s30, s31, 2054144
    s_cmp_eq_u32 s26, 15
    s_cselect_b32 s25, s30, s25
    s_cselect_b64 vcc, -1, vcc
    s_waitcnt vmcnt(6)
    s_cbranch_vccnz L_w26
    s_waitcnt vmcnt(4)
L_w26:
    buffer_load_dwordx4 v[32:35], v2, s[8:11], s25 offen nt
    v_mfma_f32_16x16x32_bf16 v[28:31], v[24:27], v[68:71], v[28:31]
    v_and_b32_dpp v24, v22, v18 row_newbcast:10 row_mask:0xf bank_mask:0xf
    v_and_b32_dpp v25, v22, v19 row_newbcast:10 row_mask:0xf bank_mask:0xf
    v_and_b32_dpp v26, v22, v20 row_newbcast:10 row_mask:0xf bank_mask:0xf
    v_and_b32_dpp v27, v22, v21 row_newbcast:10 row_mask:0xf bank_mask:0xf
    s_waitcnt lgkmcnt(0)
    v_cmp_ge_u32 vcc, v96, v12
    s_cmp_ge_u32 s26, 15
    s_nop 0
    s_cselect_b64 vcc, -1, vcc
    s_add_u32 s30, s31, 2050048
    s_cmp_eq_u32 s26, 15
    s_cselect_b32 s25, s30, s25
    s_waitcnt vmcnt(6)
    s_cbranch_vccnz L_w27
    s_waitcnt vmcnt(4)
L_w27:
    buffer_load_dwordx4 v[36:39], v2, s[8:11], s25 offen offset:2048 nt
    s_addk_i32 s25, 4096
    v_mfma_f32_16x16x32_bf16 v[28:31], v[24:27], v[72:75], v[28:31]
    v_and_b32_dpp v24, v22, v18 row_newbcast:11 row_mask:0xf bank_mask:0xf
    v_and_b32_dpp v25, v22, v19 row_newbcast:11 row_mask:0xf bank_mask:0xf
    v_and_b32_dpp v26, v22, v20 row_newbcast:11 row_mask:0xf bank_mask:0xf
    v_and_b32_dpp v27, v22, v21 row_newbcast:11 row_mask:0xf bank_mask:0xf
    s_add_u32 s30, s31, 2050048
    s_cmp_eq_u32 s26, 15
    s_cselect_b32 s25, s30, s25
    s_waitcnt vmcnt(6)
    s_cbranch_vccnz L_w28
    s_waitcnt vmcnt(4)
L_w28:
    buffer_load_dwordx4 v[40:43], v2, s[8:11], s25 offen nt
    v_mfma_f32_16x16x32_bf16 v[28:31], v[24:27], v[76:79], v[28:31]
    v_and_b32_dpp v24, v22, v18 row_newbcast:12 row_mask:0xf bank_mask:0xf
    v_and_b32_dpp v25, v22, v19 row_newbcast:12 row_mask:0xf bank_mask:0xf
    v_and_b32_dpp v26, v22, v20 row_newbcast:12 row_mask:0xf bank_mask:0xf
    v_and_b32_dpp v27, v22, v21 row_newbcast:12 row_mask:0xf bank_mask:0xf
    s_cmp_eq_u32 s26, 15
    s_cselect_b32 s10, 0, s10
    s_waitcnt vmcnt(6)
    s_cbranch_vccnz L_w29
    s_waitcnt vmcnt(4)
L_w29:
    buffer_load_dwordx4 v[44:47], v2, s[8:11], s25 offen offset:2048 nt
    s_addk_i32 s25, 12288
    v_mfma_f32_16x16x32_bf16 v[28:31], v[24:27], v[80:83], v[28:31]
    v_and_b32_dpp v24, v22, v18 row_newbcast:13 row_mask:0xf bank_mask:0xf
    v_and_b32_dpp v25, v22, v19 row_newbcast:13 row_mask:0xf bank_mask:0xf
    v_and_b32_dpp v26, v22, v20 row_newbcast:13 row_mask:0xf bank_mask:0xf
    v_and_b32_dpp v27, v22, v21 row_newbcast:13 row_mask:0xf bank_mask:0xf
    s_waitcnt vmcnt(6)
    s_cbranch_vccnz L_w30
    s_waitcnt vmcnt(4)
L_w30:
    buffer_load_dwordx4 v[48:51], v2, s[8:11], s25 offen nt
    v_mfma_f32_16x16x32_bf16 v[28:31], v[24:27], v[84:87], v[28:31]
    v_and_b32_dpp v24, v22, v18 row_newbcast:14 row_mask:0xf bank_mask:0xf
    v_and_b32_dpp v25, v22, v19 row_newbcast:14 row_mask:0xf bank_mask:0xf
    v_and_b32_dpp v26, v22, v20 row_newbcast:14 row_mask:0xf bank_mask:0xf
    v_and_b32_dpp v27, v22, v21 row_newbcast:14 row_mask:0xf bank_mask:0xf
    s_waitcnt vmcnt(6)
    s_cbranch_vccnz L_w31
    s_waitcnt vmcnt(4)
L_w31:
    buffer_load_dwordx4 v[52:55], v2, s[8:11], s25 offen offset:2048 nt
    s_addk_i32 s25, 4096
    v_mfma_f32_16x16x32_bf16 v[28:31], v[24:27], v[88:91], v[28:31]
    v_and_b32_dpp v24, v22, v18 row_newbcast:15 row_mask:0xf bank_mask:0xf
    v_and_b32_dpp v25, v22, v19 row_newbcast:15 row_mask:0xf bank_mask:0xf
    v_and_b32_dpp v26, v22, v20 row_newbcast:15 row_mask:0xf bank_mask:0xf
    v_and_b32_dpp v27, v22, v21 row_newbcast:15 row_mask:0xf bank_mask:0xf
    s_waitcnt vmcnt(6)
    s_cbranch_vccnz L_w32
    s_waitcnt vmcnt(4)
L_w32:
    buffer_load_dwordx4 v[56:59], v2, s[8:11], s25 offen nt
    v_mfma_f32_16x16x32_bf16 v[28:31], v[24:27], v[92:95], v[28:31]
    v_and_b32_dpp v24, v23, v18 row_newbcast:0 row_mask:0xf bank_mask:0xf
    v_and_b32_dpp v25, v23, v19 row_newbcast:0 row_mask:0xf bank_mask:0xf
    v_and_b32_dpp v26, v23, v20 row_newbcast:0 row_mask:0xf bank_mask:0xf
    v_and_b32_dpp v27, v23, v21 row_newbcast:0 row_mask:0xf bank_mask:0xf
    v_mov_b32 v22, v23
    s_add_u32 s26, s26, 1
    s_cmp_lt_u32 s26, 16
    s_cbranch_scc1 L_vloop
    v_cvt_pk_bf16_f32 v106, v28, v29
    v_cvt_pk_bf16_f32 v107, v30, v31
    ds_write_b64 v100, v[106:107] offset:18432
    s_waitcnt lgkmcnt(0)
    s_barrier
    s_or_b32 s17, s20, s23
    s_cbranch_scc1 L_end
    ds_read_b64 v[108:109], v103 offset:19776
    ds_read_b128 v[112:115], v104 offset:20032
    s_mov_b32 s26, 262144
    s_waitcnt lgkmcnt(0)
    v_add_f32 v112, v112, v113
    v_add_f32 v112, v112, v114
    v_cvt_pk_bf16_f32 v112, 0, v112
    v_add_f32 v109, v112, v109
    v_cvt_pk_bf16_f32 v109, 0, v109
L_zpoll:
    global_load_dwordx4 v[124:127], v101, s[56:57] offset:0 sc1
    global_load_dwordx4 v[128:131], v101, s[56:57] offset:1024 sc1
    global_load_dwordx4 v[132:135], v101, s[56:57] offset:2048 sc1
    global_load_dwordx4 v[136:139], v101, s[56:57] offset:3072 sc1
    s_mov_b64 exec, -1
    s_sub_u32 s26, s26, 1
    s_cselect_b64 s[4:5], 0, -1
    s_waitcnt vmcnt(3)
    v_mfma_f32_16x16x32_bf16 v[140:143], v[148:151], v[124:127], 0
    v_max_u32 v120, v124, v125
    v_max3_u32 v120, v126, v127, v120
    s_waitcnt vmcnt(2)
    v_mfma_f32_16x16x32_bf16 v[140:143], v[148:151], v[128:131], v[140:143]
    v_max3_u32 v120, v128, v129, v120
    v_max3_u32 v120, v130, v131, v120
    s_waitcnt vmcnt(1)
    v_mfma_f32_16x16x32_bf16 v[140:143], v[148:151], v[132:135], v[140:143]
    v_max3_u32 v120, v132, v133, v120
    v_max3_u32 v120, v134, v135, v120
    s_waitcnt vmcnt(0)
    v_mfma_f32_16x16x32_bf16 v[140:143], v[148:151], v[136:139], v[140:143]
    v_max3_u32 v120, v136, v137, v120
    v_max3_u32 v120, v138, v139, v120
    v_cmp_eq_u32 vcc, -1, v120
    s_nop 1
    s_and_b64 exec, vcc, s[4:5]
    s_cbranch_execnz L_zpoll
L_zdone:
    s_mov_b64 exec, -1
    v_add_f32_dpp v144, v140, v140 row_ror:8 row_mask:0xf bank_mask:0x3
    v_add_f32_dpp v145, v141, v141 row_ror:8 row_mask:0xf bank_mask:0x3
    s_nop 0
    v_add_f32_dpp v144, v142, v142 row_ror:8 row_mask:0xf bank_mask:0xc
    v_add_f32_dpp v145, v143, v143 row_ror:8 row_mask:0xf bank_mask:0xc
    s_nop 0
    v_add_f32_dpp v116, v144, v144 row_shl:4 row_mask:0xf bank_mask:0x5
    s_nop 1
    v_add_f32_dpp v116, v145, v145 row_shr:4 row_mask:0xf bank_mask:0xa
    v_cvt_pk_bf16_f32 v116, 0, v116
    v_add_f32 v116, v108, v116
    v_cvt_pk_bf16_f32 v116, 0, v116
    v_add_f32 v116, v116, v109
    v_cvt_pk_bf16_f32 v116, v116, v116
    s_mov_b32 exec_hi, 0
    global_store_short v102, v116, s[52:53]
L_end:
    s_endpgm
L_helper:
    s_load_dwordx8 s[48:55], s[0:1], 64
    s_load_dwordx2 s[56:57], s[0:1], 96
    s_lshr_b32 s20, s20, 6
    v_and_b32 v1, 63, v0
    s_bfe_u32 s23, s2, 0x10005
    s_mov_b32 s11, 0x20000
    s_lshr_b32 s21, s2, 6
    s_sub_u32 s16, s20, 4
    s_and_b32 s24, s2, 63
    v_lshlrev_b32 v3, 4, v1
    v_lshrrev_b32 v6, 4, v1
    v_and_b32 v7, 15, v1
    s_lshl_b32 s17, s16, 20
    s_lshl_b32 s18, s22, 8
    s_add_u32 s17, s17, s18
    v_lshlrev_b32 v2, 17, v6
    v_lshl_add_u32 v2, v7, 4, v2
    v_add_u32 v2, s17, v2
    s_lshl_b32 s17, s16, 8
    v_lshl_add_u32 v4, v1, 1, s17
    s_lshr_b32 s15, s2, 5
    v_xor_b32 v14, 0x80, v4
    s_and_b32 s17, s2, 15
    s_lshl_b32 s19, s17, 6
    v_and_b32 v5, 31, v1
    v_lshl_add_u32 v5, v5, 1, s19
    s_lshl_b32 s17, s21, 10
    s_mov_b32 s10, 0x400000
    s_waitcnt lgkmcnt(0)
    s_add_u32 s30, s32, s17
    s_addc_u32 s31, s33, 0
    s_mov_b32 s8, s38
    s_mov_b32 s9, s39
    s_lshl_b32 s18, s21, 2
    v_mov_b32 v10, s18
    v_mov_b32 v11, 1
    v_mov_b32 v9, 0
    s_mov_b32 s25, 0
    buffer_load_dwordx4 v[32:35], v2, s[8:11], s25 offen
    s_mov_b32 s25, 8192
    buffer_load_dwordx4 v[36:39], v2, s[8:11], s25 offen
    s_mov_b32 s25, 16384
    buffer_load_dwordx4 v[40:43], v2, s[8:11], s25 offen
    s_cmp_lg_u32 s16, 0
    s_cbranch_scc1 L_noxpf
    s_lshr_b32 s17, s2, 3
    s_lshl_b32 s17, s17, 7
    s_load_dword s6, s[32:33], s17
L_noxpf:
    v_and_b32 v12, 1, v1
    v_lshlrev_b32 v12, 4, v12
    v_mov_b32 v13, 0xffff
    v_lshlrev_b32 v13, v12, v13
    v_bfe_u32 v12, v1, 1, 2
    v_cmp_eq_u32 vcc, 0, v12
    s_nop 1
    v_cndmask_b32 v18, 0, v13, vcc
    v_cmp_eq_u32 vcc, 1, v12
    s_nop 1
    v_cndmask_b32 v19, 0, v13, vcc
    v_cmp_eq_u32 vcc, 2, v12
    s_nop 1
    v_cndmask_b32 v20, 0, v13, vcc
    v_cmp_eq_u32 vcc, 3, v12
    s_nop 1
    v_cndmask_b32 v21, 0, v13, vcc
    s_lshl_b32 s17, s24, 2
    s_add_u32 s17, s17, s16
    s_cmp_lg_u32 s17, 1
    s_cbranch_scc1 L_noroot
    s_mov_b64 exec, 1023
    s_mul_i32 s17, s2, 4224
    s_add_u32 s17, s17, 1048576
    v_mul_u32_u24 v226, 4224, v1
    v_add_u32 v226, s17, v226
    global_store_dword v226, v9, s[56:57] sc1
    s_mov_b64 exec, 1
    s_waitcnt vmcnt(0)
    global_store_dword v10, v11, s[54:55] sc1
    s_mov_b64 exec, -1
L_noroot:
    v_mov_b32 v8, 19712
    v_lshl_add_u32 v8, s16, 2, v8
    ds_write_b32 v8, v9
    ds_write_b32 v9, v9 offset:19744
    ds_write_b32 v9, v9 offset:19748
    s_waitcnt vmcnt(2)
    s_mov_b32 s25, 24576
    buffer_load_dwordx4 v[44:47], v2, s[8:11], s25 offen
    s_waitcnt vmcnt(2)
    s_mov_b32 s25, 32768
    buffer_load_dwordx4 v[48:51], v2, s[8:11], s25 offen
    s_waitcnt vmcnt(2)
    s_mov_b32 s25, 40960
    buffer_load_dwordx4 v[52:55], v2, s[8:11], s25 offen
    global_load_dwordx4 v[160:163], v3, s[30:31]
    global_load_ushort v164, v4, s[30:31]
    global_load_ushort v165, v14, s[30:31]
    global_load_ushort v166, v5, s[30:31]
    s_waitcnt vmcnt(6)
    s_mov_b32 s25, 49152
    buffer_load_dwordx4 v[56:59], v2, s[8:11], s25 offen
    s_waitcnt vmcnt(6)
    s_mov_b32 s25, 57344
    buffer_load_dwordx4 v[60:63], v2, s[8:11], s25 offen
    s_waitcnt vmcnt(6)
    s_mov_b32 s25, 65536
    buffer_load_dwordx4 v[64:67], v2, s[8:11], s25 offen
    s_waitcnt vmcnt(2)
    s_mov_b32 s25, 73728
    buffer_load_dwordx4 v[68:71], v2, s[8:11], s25 offen
    v_lshlrev_b32 v168, 16, v160
    v_and_b32 v169, 0xffff0000, v160
    v_lshlrev_b32 v170, 16, v161
    v_and_b32 v171, 0xffff0000, v161
    v_lshlrev_b32 v172, 16, v162
    v_and_b32 v173, 0xffff0000, v162
    v_lshlrev_b32 v174, 16, v163
    v_and_b32 v175, 0xffff0000, v163
    v_lshlrev_b32 v164, 16, v164
    v_lshlrev_b32 v165, 16, v165
    v_lshlrev_b32 v166, 16, v166
    v_add_f32 v176, v168, v169
    v_add_f32 v177, v170, v171
    v_add_f32 v178, v172, v173
    v_add_f32 v179, v174, v175
    v_add_f32 v176, v176, v177
    v_add_f32 v178, v178, v179
    v_add_f32 v176, v176, v178
    s_nop 1
    v_add_f32_dpp v176, v176, v176 quad_perm:[1,0,3,2] row_mask:0xf bank_mask:0xf
    s_nop 1
    v_add_f32_dpp v176, v176, v176 quad_perm:[2,3,0,1] row_mask:0xf bank_mask:0xf
    s_nop 1
    v_add_f32_dpp v176, v176, v176 row_half_mirror row_mask:0xf bank_mask:0xf
    s_nop 1
    v_add_f32_dpp v176, v176, v176 row_mirror row_mask:0xf bank_mask:0xf
    s_nop 1
    v_add_f32_dpp v176, v176, v176 row_bcast:15 row_mask:0xa bank_mask:0xf
    s_nop 1
    v_add_f32_dpp v176, v176, v176 row_bcast:31 row_mask:0xc bank_mask:0xf
    s_nop 0
    v_readlane_b32 s17, v176, 63
    v_mov_b32 v177, 0x3b000000
    s_nop 0
    v_mul_f32 v184, s17, v177
    v_sub_f32 v178, v168, v184
    v_mul_f32 v176, v178, v178
    v_sub_f32 v178, v169, v184
    v_fmac_f32 v176, v178, v178
    v_sub_f32 v178, v170, v184
    v_fmac_f32 v176, v178, v178
    v_sub_f32 v178, v171, v184
    v_fmac_f32 v176, v178, v178
    v_sub_f32 v178, v172, v184
    v_fmac_f32 v176, v178, v178
    v_sub_f32 v178, v173, v184
    v_fmac_f32 v176, v178, v178
    v_sub_f32 v178, v174, v184
    v_fmac_f32 v176, v178, v178
    v_sub_f32 v178, v175, v184
    v_fmac_f32 v176, v178, v178
    s_nop 1
    v_add_f32_dpp v176, v176, v176 quad_perm:[1,0,3,2] row_mask:0xf bank_mask:0xf
    s_nop 1
    v_add_f32_dpp v176, v176, v176 quad_perm:[2,3,0,1] row_mask:0xf bank_mask:0xf
    s_nop 1
    v_add_f32_dpp v176, v176, v176 row_half_mirror row_mask:0xf bank_mask:0xf
    s_nop 1
    v_add_f32_dpp v176, v176, v176 row_mirror row_mask:0xf bank_mask:0xf
    s_nop 1
    v_add_f32_dpp v176, v176, v176 row_bcast:15 row_mask:0xa bank_mask:0xf
    s_nop 1
    v_add_f32_dpp v176, v176, v176 row_bcast:31 row_mask:0xc bank_mask:0xf
    s_nop 0
    v_readlane_b32 s17, v176, 63
    s_nop 1
    v_mul_f32 v176, s17, v177
    v_cvt_pk_bf16_f32 v176, 0, v176
    v_add_f32 v176, 0x3727c5ac, v176
    v_cvt_pk_bf16_f32 v176, 0, v176
    v_sqrt_f32 v176, v176
    v_cvt_pk_bf16_f32 v184, 0, v184
    v_cvt_pk_bf16_f32 v176, 0, v176
    v_rcp_f32 v185, v176
    v_sub_f32 v22, v164, v184
    v_cvt_pk_bf16_f32 v22, 0, v22
    v_mul_f32 v22, v22, v185
    v_cvt_pk_bf16_f32 v22, v22, v22
    v_sub_f32 v23, v165, v184
    v_cvt_pk_bf16_f32 v23, 0, v23
    v_mul_f32 v23, v23, v185
    v_cvt_pk_bf16_f32 v23, v23, v23
    v_and_b32_dpp v24, v22, v18 row_newbcast:0 row_mask:0xf bank_mask:0xf
    v_and_b32_dpp v25, v22, v19 row_newbcast:0 row_mask:0xf bank_mask:0xf
    v_and_b32_dpp v26, v22, v20 row_newbcast:0 row_mask:0xf bank_mask:0xf
    v_and_b32_dpp v27, v22, v21 row_newbcast:0 row_mask:0xf bank_mask:0xf
    s_waitcnt vmcnt(2)
    s_mov_b32 s25, 81920
    buffer_load_dwordx4 v[72:75], v2, s[8:11], s25 offen
    v_mfma_f32_16x16x32_bf16 v[28:31], v[24:27], v[32:35], 0
    v_lshlrev_b32 v176, 5, v7
    v_and_b32 v177, 16, v1
    s_lshl_b32 s17, s16, 9
    v_add3_u32 v176, v176, v177, s17
    v_and_b32_dpp v24, v22, v18 row_newbcast:1 row_mask:0xf bank_mask:0xf
    v_and_b32_dpp v25, v22, v19 row_newbcast:1 row_mask:0xf bank_mask:0xf
    v_and_b32_dpp v26, v22, v20 row_newbcast:1 row_mask:0xf bank_mask:0xf
    v_and_b32_dpp v27, v22, v21 row_newbcast:1 row_mask:0xf bank_mask:0xf
    s_nop 1
    v_mfma_f32_16x16x32_bf16 v[28:31], v[24:27], v[36:39], v[28:31]
    v_and_b32_dpp v24, v22, v18 row_newbcast:2 row_mask:0xf bank_mask:0xf
    v_and_b32_dpp v25, v22, v19 row_newbcast:2 row_mask:0xf bank_mask:0xf
    v_and_b32_dpp v26, v22, v20 row_newbcast:2 row_mask:0xf bank_mask:0xf
    v_and_b32_dpp v27, v22, v21 row_newbcast:2 row_mask:0xf bank_mask:0xf
    s_nop 1
    v_mfma_f32_16x16x32_bf16 v[28:31], v[24:27], v[40:43], v[28:31]
    v_and_b32_dpp v24, v22, v18 row_newbcast:3 row_mask:0xf bank_mask:0xf
    v_and_b32_dpp v25, v22, v19 row_newbcast:3 row_mask:0xf bank_mask:0xf
    v_and_b32_dpp v26, v22, v20 row_newbcast:3 row_mask:0xf bank_mask:0xf
    v_and_b32_dpp v27, v22, v21 row_newbcast:3 row_mask:0xf bank_mask:0xf
    s_waitcnt vmcnt(2)
    s_mov_b32 s25, 90112
    buffer_load_dwordx4 v[76:79], v2, s[8:11], s25 offen
    v_mfma_f32_16x16x32_bf16 v[28:31], v[24:27], v[44:47], v[28:31]
    v_and_b32_dpp v24, v22, v18 row_newbcast:4 row_mask:0xf bank_mask:0xf
    v_and_b32_dpp v25, v22, v19 row_newbcast:4 row_mask:0xf bank_mask:0xf
    v_and_b32_dpp v26, v22, v20 row_newbcast:4 row_mask:0xf bank_mask:0xf
    v_and_b32_dpp v27, v22, v21 row_newbcast:4 row_mask:0xf bank_mask:0xf
    s_nop 1
    v_mfma_f32_16x16x32_bf16 v[28:31], v[24:27], v[48:51], v[28:31]
    v_and_b32_dpp v24, v22, v18 row_newbcast:5 row_mask:0xf bank_mask:0xf
    v_and_b32_dpp v25, v22, v19 row_newbcast:5 row_mask:0xf bank_mask:0xf
    v_and_b32_dpp v26, v22, v20 row_newbcast:5 row_mask:0xf bank_mask:0xf
    v_and_b32_dpp v27, v22, v21 row_newbcast:5 row_mask:0xf bank_mask:0xf
    s_nop 1
    v_mfma_f32_16x16x32_bf16 v[28:31], v[24:27], v[52:55], v[28:31]
    v_and_b32_dpp v24, v22, v18 row_newbcast:6 row_mask:0xf bank_mask:0xf
    v_and_b32_dpp v25, v22, v19 row_newbcast:6 row_mask:0xf bank_mask:0xf
    v_and_b32_dpp v26, v22, v20 row_newbcast:6 row_mask:0xf bank_mask:0xf
    v_and_b32_dpp v27, v22, v21 row_newbcast:6 row_mask:0xf bank_mask:0xf
    s_waitcnt vmcnt(2)
    s_mov_b32 s25, 98304
    buffer_load_dwordx4 v[80:83], v2, s[8:11], s25 offen
    v_mfma_f32_16x16x32_bf16 v[28:31], v[24:27], v[56:59], v[28:31]
    v_and_b32_dpp v24, v22, v18 row_newbcast:7 row_mask:0xf bank_mask:0xf
    v_and_b32_dpp v25, v22, v19 row_newbcast:7 row_mask:0xf bank_mask:0xf
    v_and_b32_dpp v26, v22, v20 row_newbcast:7 row_mask:0xf bank_mask:0xf
    v_and_b32_dpp v27, v22, v21 row_newbcast:7 row_mask:0xf bank_mask:0xf
    s_nop 1
    v_mfma_f32_16x16x32_bf16 v[28:31], v[24:27], v[60:63], v[28:31]
    v_and_b32_dpp v24, v22, v18 row_newbcast:8 row_mask:0xf bank_mask:0xf
    v_and_b32_dpp v25, v22, v19 row_newbcast:8 row_mask:0xf bank_mask:0xf
    v_and_b32_dpp v26, v22, v20 row_newbcast:8 row_mask:0xf bank_mask:0xf
    v_and_b32_dpp v27, v22, v21 row_newbcast:8 row_mask:0xf bank_mask:0xf
    s_nop 1
    v_mfma_f32_16x16x32_bf16 v[28:31], v[24:27], v[64:67], v[28:31]
    v_and_b32_dpp v24, v22, v18 row_newbcast:9 row_mask:0xf bank_mask:0xf
    v_and_b32_dpp v25, v22, v19 row_newbcast:9 row_mask:0xf bank_mask:0xf
    v_and_b32_dpp v26, v22, v20 row_newbcast:9 row_mask:0xf bank_mask:0xf
    v_and_b32_dpp v27, v22, v21 row_newbcast:9 row_mask:0xf bank_mask:0xf
    s_waitcnt vmcnt(2)
    s_mov_b32 s25, 106496
    buffer_load_dwordx4 v[84:87], v2, s[8:11], s25 offen
    v_mfma_f32_16x16x32_bf16 v[28:31], v[24:27], v[68:71], v[28:31]
    v_and_b32_dpp v24, v22, v18 row_newbcast:10 row_mask:0xf bank_mask:0xf
    v_and_b32_dpp v25, v22, v19 row_newbcast:10 row_mask:0xf bank_mask:0xf
    v_and_b32_dpp v26, v22, v20 row_newbcast:10 row_mask:0xf bank_mask:0xf
    v_and_b32_dpp v27, v22, v21 row_newbcast:10 row_mask:0xf bank_mask:0xf
    s_waitcnt vmcnt(2)
    s_mov_b32 s25, 114688
    buffer_load_dwordx4 v[88:91], v2, s[8:11], s25 offen
    v_mfma_f32_16x16x32_bf16 v[28:31], v[24:27], v[72:75], v[28:31]
    v_and_b32_dpp v24, v22, v18 row_newbcast:11 row_mask:0xf bank_mask:0xf
    v_and_b32_dpp v25, v22, v19 row_newbcast:11 row_mask:0xf bank_mask:0xf
    v_and_b32_dpp v26, v22, v20 row_newbcast:11 row_mask:0xf bank_mask:0xf
    v_and_b32_dpp v27, v22, v21 row_newbcast:11 row_mask:0xf bank_mask:0xf
    s_waitcnt vmcnt(2)
    s_mov_b32 s25, 122880
    buffer_load_dwordx4 v[92:95], v2, s[8:11], s25 offen
    v_mfma_f32_16x16x32_bf16 v[28:31], v[24:27], v[76:79], v[28:31]
    v_and_b32_dpp v24, v22, v18 row_newbcast:12 row_mask:0xf bank_mask:0xf
    v_and_b32_dpp v25, v22, v19 row_newbcast:12 row_mask:0xf bank_mask:0xf
    v_and_b32_dpp v26, v22, v20 row_newbcast:12 row_mask:0xf bank_mask:0xf
    v_and_b32_dpp v27, v22, v21 row_newbcast:12 row_mask:0xf bank_mask:0xf
    s_waitcnt vmcnt(2)
    s_mov_b32 s25, 524288
    buffer_load_dwordx4 v[96:99], v2, s[8:11], s25 offen
    v_mfma_f32_16x16x32_bf16 v[28:31], v[24:27], v[80:83], v[28:31]
    v_and_b32_dpp v24, v22, v18 row_newbcast:13 row_mask:0xf bank_mask:0xf
    v_and_b32_dpp v25, v22, v19 row_newbcast:13 row_mask:0xf bank_mask:0xf
    v_and_b32_dpp v26, v22, v20 row_newbcast:13 row_mask:0xf bank_mask:0xf
    v_and_b32_dpp v27, v22, v21 row_newbcast:13 row_mask:0xf bank_mask:0xf
    s_waitcnt vmcnt(2)
    s_mov_b32 s25, 532480
    buffer_load_dwordx4 v[100:103], v2, s[8:11], s25 offen
    v_mfma_f32_16x16x32_bf16 v[28:31], v[24:27], v[84:87], v[28:31]
    v_and_b32_dpp v24, v22, v18 row_newbcast:14 row_mask:0xf bank_mask:0xf
    v_and_b32_dpp v25, v22, v19 row_newbcast:14 row_mask:0xf bank_mask:0xf
    v_and_b32_dpp v26, v22, v20 row_newbcast:14 row_mask:0xf bank_mask:0xf
    v_and_b32_dpp v27, v22, v21 row_newbcast:14 row_mask:0xf bank_mask:0xf
    s_waitcnt vmcnt(2)
    s_mov_b32 s25, 540672
    buffer_load_dwordx4 v[104:107], v2, s[8:11], s25 offen
    v_mfma_f32_16x16x32_bf16 v[28:31], v[24:27], v[88:91], v[28:31]
    v_and_b32_dpp v24, v22, v18 row_newbcast:15 row_mask:0xf bank_mask:0xf
    v_and_b32_dpp v25, v22, v19 row_newbcast:15 row_mask:0xf bank_mask:0xf
    v_and_b32_dpp v26, v22, v20 row_newbcast:15 row_mask:0xf bank_mask:0xf
    v_and_b32_dpp v27, v22, v21 row_newbcast:15 row_mask:0xf bank_mask:0xf
    s_waitcnt vmcnt(2)
    s_mov_b32 s25, 548864
    buffer_load_dwordx4 v[108:111], v2, s[8:11], s25 offen
    v_mfma_f32_16x16x32_bf16 v[28:31], v[24:27], v[92:95], v[28:31]
    v_and_b32_dpp v24, v23, v18 row_newbcast:0 row_mask:0xf bank_mask:0xf
    v_and_b32_dpp v25, v23, v19 row_newbcast:0 row_mask:0xf bank_mask:0xf
    v_and_b32_dpp v26, v23, v20 row_newbcast:0 row_mask:0xf bank_mask:0xf
    v_and_b32_dpp v27, v23, v21 row_newbcast:0 row_mask:0xf bank_mask:0xf
    s_waitcnt vmcnt(2)
    s_mov_b32 s25, 557056
    buffer_load_dwordx4 v[112:115], v2, s[8:11], s25 offen
    v_mfma_f32_16x16x32_bf16 v[28:31], v[24:27], v[96:99], v[28:31]
    v_and_b32_dpp v24, v23, v18 row_newbcast:1 row_mask:0xf bank_mask:0xf
    v_and_b32_dpp v25, v23, v19 row_newbcast:1 row_mask:0xf bank_mask:0xf
    v_and_b32_dpp v26, v23, v20 row_newbcast:1 row_mask:0xf bank_mask:0xf
    v_and_b32_dpp v27, v23, v21 row_newbcast:1 row_mask:0xf bank_mask:0xf
    s_waitcnt vmcnt(2)
    s_mov_b32 s25, 565248
    buffer_load_dwordx4 v[116:119], v2, s[8:11], s25 offen
    v_mfma_f32_16x16x32_bf16 v[28:31], v[24:27], v[100:103], v[28:31]
    v_and_b32_dpp v24, v23, v18 row_newbcast:2 row_mask:0xf bank_mask:0xf
    v_and_b32_dpp v25, v23, v19 row_newbcast:2 row_mask:0xf bank_mask:0xf
    v_and_b32_dpp v26, v23, v20 row_newbcast:2 row_mask:0xf bank_mask:0xf
    v_and_b32_dpp v27, v23, v21 row_newbcast:2 row_mask:0xf bank_mask:0xf
    s_waitcnt vmcnt(2)
    s_mov_b32 s25, 573440
    buffer_load_dwordx4 v[120:123], v2, s[8:11], s25 offen
    v_mfma_f32_16x16x32_bf16 v[28:31], v[24:27], v[104:107], v[28:31]
    v_and_b32_dpp v24, v23, v18 row_newbcast:3 row_mask:0xf bank_mask:0xf
    v_and_b32_dpp v25, v23, v19 row_newbcast:3 row_mask:0xf bank_mask:0xf
    v_and_b32_dpp v26, v23, v20 row_newbcast:3 row_mask:0xf bank_mask:0xf
    v_and_b32_dpp v27, v23, v21 row_newbcast:3 row_mask:0xf bank_mask:0xf
    s_waitcnt vmcnt(2)
    s_mov_b32 s25, 581632
    buffer_load_dwordx4 v[124:127], v2, s[8:11], s25 offen
    v_mfma_f32_16x16x32_bf16 v[28:31], v[24:27], v[108:111], v[28:31]
    v_and_b32_dpp v24, v23, v18 row_newbcast:4 row_mask:0xf bank_mask:0xf
    v_and_b32_dpp v25, v23, v19 row_newbcast:4 row_mask:0xf bank_mask:0xf
    v_and_b32_dpp v26, v23, v20 row_newbcast:4 row_mask:0xf bank_mask:0xf
    v_and_b32_dpp v27, v23, v21 row_newbcast:4 row_mask:0xf bank_mask:0xf
    s_waitcnt vmcnt(2)
    s_mov_b32 s25, 589824
    buffer_load_dwordx4 v[128:131], v2, s[8:11], s25 offen
    v_mfma_f32_16x16x32_bf16 v[28:31], v[24:27], v[112:115], v[28:31]
    v_and_b32_dpp v24, v23, v18 row_newbcast:5 row_mask:0xf bank_mask:0xf
    v_and_b32_dpp v25, v23, v19 row_newbcast:5 row_mask:0xf bank_mask:0xf
    v_and_b32_dpp v26, v23, v20 row_newbcast:5 row_mask:0xf bank_mask:0xf
    v_and_b32_dpp v27, v23, v21 row_newbcast:5 row_mask:0xf bank_mask:0xf
    s_waitcnt vmcnt(2)
    s_mov_b32 s25, 598016
    buffer_load_dwordx4 v[132:135], v2, s[8:11], s25 offen
    v_mfma_f32_16x16x32_bf16 v[28:31], v[24:27], v[116:119], v[28:31]
    v_and_b32_dpp v24, v23, v18 row_newbcast:6 row_mask:0xf bank_mask:0xf
    v_and_b32_dpp v25, v23, v19 row_newbcast:6 row_mask:0xf bank_mask:0xf
    v_and_b32_dpp v26, v23, v20 row_newbcast:6 row_mask:0xf bank_mask:0xf
    v_and_b32_dpp v27, v23, v21 row_newbcast:6 row_mask:0xf bank_mask:0xf
    s_waitcnt vmcnt(2)
    s_mov_b32 s25, 606208
    buffer_load_dwordx4 v[136:139], v2, s[8:11], s25 offen
    v_mfma_f32_16x16x32_bf16 v[28:31], v[24:27], v[120:123], v[28:31]
    v_and_b32_dpp v24, v23, v18 row_newbcast:7 row_mask:0xf bank_mask:0xf
    v_and_b32_dpp v25, v23, v19 row_newbcast:7 row_mask:0xf bank_mask:0xf
    v_and_b32_dpp v26, v23, v20 row_newbcast:7 row_mask:0xf bank_mask:0xf
    v_and_b32_dpp v27, v23, v21 row_newbcast:7 row_mask:0xf bank_mask:0xf
    s_waitcnt vmcnt(2)
    s_mov_b32 s25, 614400
    buffer_load_dwordx4 v[140:143], v2, s[8:11], s25 offen
    v_mfma_f32_16x16x32_bf16 v[28:31], v[24:27], v[124:127], v[28:31]
    v_and_b32_dpp v24, v23, v18 row_newbcast:8 row_mask:0xf bank_mask:0xf
    v_and_b32_dpp v25, v23, v19 row_newbcast:8 row_mask:0xf bank_mask:0xf
    v_and_b32_dpp v26, v23, v20 row_newbcast:8 row_mask:0xf bank_mask:0xf
    v_and_b32_dpp v27, v23, v21 row_newbcast:8 row_mask:0xf bank_mask:0xf
    s_waitcnt vmcnt(1)
    s_mov_b32 s25, 622592
    buffer_load_dwordx4 v[144:147], v2, s[8:11], s25 offen
    v_mfma_f32_16x16x32_bf16 v[28:31], v[24:27], v[128:131], v[28:31]
    v_and_b32_dpp v24, v23, v18 row_newbcast:9 row_mask:0xf bank_mask:0xf
    v_and_b32_dpp v25, v23, v19 row_newbcast:9 row_mask:0xf bank_mask:0xf
    v_and_b32_dpp v26, v23, v20 row_newbcast:9 row_mask:0xf bank_mask:0xf
    v_and_b32_dpp v27, v23, v21 row_newbcast:9 row_mask:0xf bank_mask:0xf
    s_waitcnt vmcnt(1)
    s_mov_b32 s25, 630784
    buffer_load_dwordx4 v[148:151], v2, s[8:11], s25 offen
    v_mfma_f32_16x16x32_bf16 v[28:31], v[24:27], v[132:135], v[28:31]
    v_and_b32_dpp v24, v23, v18 row_newbcast:10 row_mask:0xf bank_mask:0xf
    v_and_b32_dpp v25, v23, v19 row_newbcast:10 row_mask:0xf bank_mask:0xf
    v_and_b32_dpp v26, v23, v20 row_newbcast:10 row_mask:0xf bank_mask:0xf
    v_and_b32_dpp v27, v23, v21 row_newbcast:10 row_mask:0xf bank_mask:0xf
    s_waitcnt vmcnt(1)
    s_mov_b32 s25, 638976
    buffer_load_dwordx4 v[152:155], v2, s[8:11], s25 offen
    v_mfma_f32_16x16x32_bf16 v[28:31], v[24:27], v[136:139], v[28:31]
    v_and_b32_dpp v24, v23, v18 row_newbcast:11 row_mask:0xf bank_mask:0xf
    v_and_b32_dpp v25, v23, v19 row_newbcast:11 row_mask:0xf bank_mask:0xf
    v_and_b32_dpp v26, v23, v20 row_newbcast:11 row_mask:0xf bank_mask:0xf
    v_and_b32_dpp v27, v23, v21 row_newbcast:11 row_mask:0xf bank_mask:0xf
    s_waitcnt vmcnt(1)
    s_mov_b32 s25, 647168
    buffer_load_dwordx4 v[156:159], v2, s[8:11], s25 offen
    v_mfma_f32_16x16x32_bf16 v[28:31], v[24:27], v[140:143], v[28:31]
    v_and_b32_dpp v24, v23, v18 row_newbcast:12 row_mask:0xf bank_mask:0xf
    v_and_b32_dpp v25, v23, v19 row_newbcast:12 row_mask:0xf bank_mask:0xf
    v_and_b32_dpp v26, v23, v20 row_newbcast:12 row_mask:0xf bank_mask:0xf
    v_and_b32_dpp v27, v23, v21 row_newbcast:12 row_mask:0xf bank_mask:0xf
    s_waitcnt vmcnt(3)
    s_nop 0
    v_mfma_f32_16x16x32_bf16 v[28:31], v[24:27], v[144:147], v[28:31]
    v_and_b32_dpp v24, v23, v18 row_newbcast:13 row_mask:0xf bank_mask:0xf
    v_and_b32_dpp v25, v23, v19 row_newbcast:13 row_mask:0xf bank_mask:0xf
    v_and_b32_dpp v26, v23, v20 row_newbcast:13 row_mask:0xf bank_mask:0xf
    v_and_b32_dpp v27, v23, v21 row_newbcast:13 row_mask:0xf bank_mask:0xf
    s_waitcnt vmcnt(2)
    s_nop 0
    v_mfma_f32_16x16x32_bf16 v[28:31], v[24:27], v[148:151], v[28:31]
    v_and_b32_dpp v24, v23, v18 row_newbcast:14 row_mask:0xf bank_mask:0xf
    v_and_b32_dpp v25, v23, v19 row_newbcast:14 row_mask:0xf bank_mask:0xf
    v_and_b32_dpp v26, v23, v20 row_newbcast:14 row_mask:0xf bank_mask:0xf
    v_and_b32_dpp v27, v23, v21 row_newbcast:14 row_mask:0xf bank_mask:0xf
    s_waitcnt vmcnt(1)
    s_nop 0
    v_mfma_f32_16x16x32_bf16 v[28:31], v[24:27], v[152:155], v[28:31]
    v_and_b32_dpp v24, v23, v18 row_newbcast:15 row_mask:0xf bank_mask:0xf
    v_and_b32_dpp v25, v23, v19 row_newbcast:15 row_mask:0xf bank_mask:0xf
    v_and_b32_dpp v26, v23, v20 row_newbcast:15 row_mask:0xf bank_mask:0xf
    v_and_b32_dpp v27, v23, v21 row_newbcast:15 row_mask:0xf bank_mask:0xf
    s_waitcnt vmcnt(0)
    s_nop 0
    v_mfma_f32_16x16x32_bf16 v[28:31], v[24:27], v[156:159], v[28:31]
    s_nop 7
    ds_write_b128 v176, v[28:31] offset:16384
    s_waitcnt lgkmcnt(0)
    s_barrier
    s_cmp_lg_u32 s16, 1
    s_cbranch_scc1 L_noclear
    v_mov_b32 v220, -1
    v_mov_b32 v221, -1
    v_mov_b32 v222, -1
    v_mov_b32 v223, -1
    s_lshl_b32 s17, s2, 10
    v_add_u32 v224, s17, v3
    s_lshl_b32 s17, s2, 7
    s_add_u32 s17, s17, 524288
    v_mov_b32 v225, s17
    global_store_dwordx4 v224, v[220:223], s[56:57] sc1
    s_mov_b64 exec, 1
    global_store_dwordx2 v225, v[220:221], s[56:57] sc1
    s_mov_b64 exec, -1
L_noclear:
    s_barrier
    s_mov_b32 s8, s40
    s_mov_b32 s9, s41
    s_lshl_b32 s17, s22, 17
    s_lshl_b32 s18, s16, 8
    s_add_u32 s17, s17, s18
    v_lshlrev_b32 v2, 10, v6
    v_lshl_add_u32 v2, v7, 4, v2
    v_add_u32 v2, s17, v2
    s_lshl_b32 s13, s16, 15
    s_add_u32 s13, s13, 20736
    s_mov_b32 s26, 0
    s_mul_i32 s28, s15, 0
    s_mov_b32 s12, -1
    s_mov_b32 s4, 0x41044400
    s_mov_b32 s5, 0x8410410
    s_mul_i32 s7, s21, 270336
    s_add_u32 s7, s7, 1044352
    s_cmp_lg_u32 s16, 1
    s_cbranch_scc1 L_wo
    s_mov_b32 s6, 262144
L_c2poll:
    global_load_dword v220, v10, s[54:55] sc1
    s_sub_u32 s6, s6, 1
    s_cbranch_scc1 L_wo
    s_waitcnt vmcnt(0)
    v_cmp_gt_u32 vcc, 1, v220
    s_nop 1
    s_cbranch_vccnz L_c2poll
    s_ff1_i32_b64 s12, s[4:5]
    s_bitset0_b64 s[4:5], s12
    s_add_u32 s7, s7, 4224
L_wo:
    s_xor_b32 s17, s26, s28
    s_lshl_b32 s25, s17, 12
    s_lshl_b32 s17, s17, 10
    s_add_u32 m0, s13, s17
    s_waitcnt vmcnt(1)
    buffer_load_dwordx4 v2, s[8:11], s25 offen  lds
    ds_read_b32 v188, v9 offset:19712
    s_waitcnt lgkmcnt(0)
    v_cmp_gt_u32 vcc, s12, v188
    s_nop 1
    s_cbranch_vccnz L_notick
    s_mov_b32 s18, 1
    s_atomic_add s18, s[56:57], s7 glc
    s_add_u32 s12, s12, 1
    s_waitcnt lgkmcnt(0)
    s_cmp_ge_u32 s18, 32
    s_addc_u32 s12, s12, 0
    s_cmp_ge_u32 s18, 44
    s_addc_u32 s12, s12, 0
    s_cmp_ge_u32 s18, 52
    s_addc_u32 s12, s12, 0
    s_cmp_ge_u32 s18, 58
    s_addc_u32 s12, s12, 0
    s_cmp_ge_u32 s18, 62
    s_addc_u32 s12, s12, 0
    v_mov_b32 v188, s12
    ds_write_b32 v9, v188 offset:19744
    s_ff1_i32_b64 s12, s[4:5]
    s_bitset0_b64 s[4:5], s12
    s_add_u32 s7, s7, 4224
L_notick:
    s_add_u32 s26, s26, 1
    s_cmp_lt_u32 s26, 32
    s_cbranch_scc1 L_wo
    v_lshlrev_b32 v13, 3, v6
    v_bfe_u32 v12, v1, 2, 2
    v_add_u32 v13, v13, v12
    v_lshlrev_b32 v13, 8, v13
    v_and_b32 v12, 3, v1
    v_lshl_add_u32 v13, v12, 6, v13
    v_add_u32 v13, s13, v13
    s_waitcnt vmcnt(0)
    ds_read_b64_tr_b16 v[32:33], v13 offset:0
    ds_read_b64_tr_b16 v[34:35], v13 offset:1024
    ds_read_b64_tr_b16 v[36:37], v13 offset:8192
    ds_read_b64_tr_b16 v[38:39], v13 offset:9216
    ds_read_b64_tr_b16 v[40:41], v13 offset:16384
    ds_read_b64_tr_b16 v[42:43], v13 offset:17408
    ds_read_b64_tr_b16 v[44:45], v13 offset:24576
    ds_read_b64_tr_b16 v[46:47], v13 offset:25600
    s_waitcnt lgkmcnt(0)
    ds_read_b64_tr_b16 v[48:49], v13 offset:8
    ds_read_b64_tr_b16 v[50:51], v13 offset:1032
    ds_read_b64_tr_b16 v[52:53], v13 offset:8200
    ds_read_b64_tr_b16 v[54:55], v13 offset:9224
    ds_read_b64_tr_b16 v[56:57], v13 offset:16392
    ds_read_b64_tr_b16 v[58:59], v13 offset:17416
    ds_read_b64_tr_b16 v[60:61], v13 offset:24584
    ds_read_b64_tr_b16 v[62:63], v13 offset:25608
    s_waitcnt lgkmcnt(0)
    ds_read_b64_tr_b16 v[64:65], v13 offset:16
    ds_read_b64_tr_b16 v[66:67], v13 offset:1040
    ds_read_b64_tr_b16 v[68:69], v13 offset:8208
    ds_read_b64_tr_b16 v[70:71], v13 offset:9232
    ds_read_b64_tr_b16 v[72:73], v13 offset:16400
    ds_read_b64_tr_b16 v[74:75], v13 offset:17424
    ds_read_b64_tr_b16 v[76:77], v13 offset:24592
    ds_read_b64_tr_b16 v[78:79], v13 offset:25616
    s_waitcnt lgkmcnt(0)
    ds_read_b64_tr_b16 v[80:81], v13 offset:24
    ds_read_b64_tr_b16 v[82:83], v13 offset:1048
    ds_read_b64_tr_b16 v[84:85], v13 offset:8216
    ds_read_b64_tr_b16 v[86:87], v13 offset:9240
    ds_read_b64_tr_b16 v[88:89], v13 offset:16408
    ds_read_b64_tr_b16 v[90:91], v13 offset:17432
    ds_read_b64_tr_b16 v[92:93], v13 offset:24600
    ds_read_b64_tr_b16 v[94:95], v13 offset:25624
    s_waitcnt lgkmcnt(0)
    ds_read_b64_tr_b16 v[96:97], v13 offset:32
    ds_read_b64_tr_b16 v[98:99], v13 offset:1056
    ds_read_b64_tr_b16 v[100:101], v13 offset:8224
    ds_read_b64_tr_b16 v[102:103], v13 offset:9248
    ds_read_b64_tr_b16 v[104:105], v13 offset:16416
    ds_read_b64_tr_b16 v[106:107], v13 offset:17440
    ds_read_b64_tr_b16 v[108:109], v13 offset:24608
    ds_read_b64_tr_b16 v[110:111], v13 offset:25632
    s_waitcnt lgkmcnt(0)
    ds_read_b64_tr_b16 v[112:113], v13 offset:40
    ds_read_b64_tr_b16 v[114:115], v13 offset:1064
    ds_read_b64_tr_b16 v[116:117], v13 offset:8232
    ds_read_b64_tr_b16 v[118:119], v13 offset:9256
    ds_read_b64_tr_b16 v[120:121], v13 offset:16424
    ds_read_b64_tr_b16 v[122:123], v13 offset:17448
    ds_read_b64_tr_b16 v[124:125], v13 offset:24616
    ds_read_b64_tr_b16 v[126:127], v13 offset:25640
    s_waitcnt lgkmcnt(0)
    ds_read_b64_tr_b16 v[128:129], v13 offset:48
    ds_read_b64_tr_b16 v[130:131], v13 offset:1072
    ds_read_b64_tr_b16 v[132:133], v13 offset:8240
    ds_read_b64_tr_b16 v[134:135], v13 offset:9264
    ds_read_b64_tr_b16 v[136:137], v13 offset:16432
    ds_read_b64_tr_b16 v[138:139], v13 offset:17456
    ds_read_b64_tr_b16 v[140:141], v13 offset:24624
    ds_read_b64_tr_b16 v[142:143], v13 offset:25648
    s_waitcnt lgkmcnt(0)
    ds_read_b64_tr_b16 v[144:145], v13 offset:56
    ds_read_b64_tr_b16 v[146:147], v13 offset:1080
    ds_read_b64_tr_b16 v[148:149], v13 offset:8248
    ds_read_b64_tr_b16 v[150:151], v13 offset:9272
    ds_read_b64_tr_b16 v[152:153], v13 offset:16440
    ds_read_b64_tr_b16 v[154:155], v13 offset:17464
    ds_read_b64_tr_b16 v[156:157], v13 offset:24632
    ds_read_b64_tr_b16 v[158:159], v13 offset:25656
    s_waitcnt lgkmcnt(0)
    s_cmp_ge_u32 s24, 16
    s_cbranch_scc1 L_nomix
    s_cmp_eq_u32 s16, 1
    s_cbranch_scc1 L_nomix
    s_mov_b32 s10, 2752
    s_max_u32 s14, s16, 1
    s_sub_u32 s14, s14, 1
    s_lshl_b32 s17, s14, 10
    v_add_u32 v12, s17, v3
    s_mov_b32 s8, s44
    s_mov_b32 s9, s45
    buffer_load_dwordx4 v[188:191], v12, s[8:11], 0 offen
    s_mov_b32 s8, s46
    s_mov_b32 s9, s47
    buffer_load_dwordx4 v[192:195], v12, s[8:11], 0 offen
    s_mov_b32 s8, s48
    s_mov_b32 s9, s49
    buffer_load_dwordx4 v[196:199], v12, s[8:11], 0 offen
    global_load_ushort v167, v9, s[50:51]
    v_sub_f32 v168, v168, v184
    v_cvt_pk_bf16_f32 v168, 0, v168
    v_mul_f32 v168, v168, v185
    v_cvt_pk_bf16_f32 v168, 0, v168
    v_sub_f32 v169, v169, v184
    v_cvt_pk_bf16_f32 v169, 0, v169
    v_mul_f32 v169, v169, v185
    v_cvt_pk_bf16_f32 v169, 0, v169
    v_sub_f32 v170, v170, v184
    v_cvt_pk_bf16_f32 v170, 0, v170
    v_mul_f32 v170, v170, v185
    v_cvt_pk_bf16_f32 v170, 0, v170
    v_sub_f32 v171, v171, v184
    v_cvt_pk_bf16_f32 v171, 0, v171
    v_mul_f32 v171, v171, v185
    v_cvt_pk_bf16_f32 v171, 0, v171
    v_sub_f32 v172, v172, v184
    v_cvt_pk_bf16_f32 v172, 0, v172
    v_mul_f32 v172, v172, v185
    v_cvt_pk_bf16_f32 v172, 0, v172
    v_sub_f32 v173, v173, v184
    v_cvt_pk_bf16_f32 v173, 0, v173
    v_mul_f32 v173, v173, v185
    v_cvt_pk_bf16_f32 v173, 0, v173
    v_sub_f32 v174, v174, v184
    v_cvt_pk_bf16_f32 v174, 0, v174
    v_mul_f32 v174, v174, v185
    v_cvt_pk_bf16_f32 v174, 0, v174
    v_sub_f32 v175, v175, v184
    v_cvt_pk_bf16_f32 v175, 0, v175
    v_mul_f32 v175, v175, v185
    v_cvt_pk_bf16_f32 v175, 0, v175
    v_sub_f32 v186, v166, v184
    v_cvt_pk_bf16_f32 v186, 0, v186
    v_mul_f32 v186, v186, v185
    v_cvt_pk_bf16_f32 v186, 0, v186
    v_add_f32 v176, v168, v169
    v_add_f32 v177, v170, v171
    v_add_f32 v178, v172, v173
    v_add_f32 v179, v174, v175
    v_add_f32 v176, v176, v177
    v_add_f32 v178, v178, v179
    v_add_f32 v176, v176, v178
    s_nop 1
    v_add_f32_dpp v176, v176, v176 quad_perm:[1,0,3,2] row_mask:0xf bank_mask:0xf
    s_nop 1
    v_add_f32_dpp v176, v176, v176 quad_perm:[2,3,0,1] row_mask:0xf bank_mask:0xf
    s_nop 1
    v_add_f32_dpp v176, v176, v176 row_half_mirror row_mask:0xf bank_mask:0xf
    s_nop 1
    v_add_f32_dpp v176, v176, v176 row_mirror row_mask:0xf bank_mask:0xf
    s_nop 1
    v_add_f32_dpp v176, v176, v176 row_bcast:15 row_mask:0xa bank_mask:0xf
    s_nop 1
    v_add_f32_dpp v176, v176, v176 row_bcast:31 row_mask:0xc bank_mask:0xf
    s_nop 0
    v_readlane_b32 s17, v176, 63
    v_mov_b32 v177, 0x3b000000
    s_nop 0
    v_mul_f32 v184, s17, v177
    v_sub_f32 v178, v168, v184
    v_mul_f32 v176, v178, v178
    v_sub_f32 v178, v169, v184
    v_fmac_f32 v176, v178, v178
    v_sub_f32 v178, v170, v184
    v_fmac_f32 v176, v178, v178
    v_sub_f32 v178, v171, v184
    v_fmac_f32 v176, v178, v178
    v_sub_f32 v178, v172, v184
    v_fmac_f32 v176, v178, v178
    v_sub_f32 v178, v173, v184
    v_fmac_f32 v176, v178, v178
    v_sub_f32 v178, v174, v184
    v_fmac_f32 v176, v178, v178
    v_sub_f32 v178, v175, v184
    v_fmac_f32 v176, v178, v178
    s_nop 1
    v_add_f32_dpp v176, v176, v176 quad_perm:[1,0,3,2] row_mask:0xf bank_mask:0xf
    s_nop 1
    v_add_f32_dpp v176, v176, v176 quad_perm:[2,3,0,1] row_mask:0xf bank_mask:0xf
    s_nop 1
    v_add_f32_dpp v176, v176, v176 row_half_mirror row_mask:0xf bank_mask:0xf
    s_nop 1
    v_add_f32_dpp v176, v176, v176 row_mirror row_mask:0xf bank_mask:0xf
    s_nop 1
    v_add_f32_dpp v176, v176, v176 row_bcast:15 row_mask:0xa bank_mask:0xf
    s_nop 1
    v_add_f32_dpp v176, v176, v176 row_bcast:31 row_mask:0xc bank_mask:0xf
    s_nop 0
    v_readlane_b32 s17, v176, 63
    s_nop 1
    v_mul_f32 v176, s17, v177
    v_cvt_pk_bf16_f32 v176, 0, v176
    v_add_f32 v176, 0x3727c5ac, v176
    v_cvt_pk_bf16_f32 v176, 0, v176
    v_sqrt_f32 v176, v176
    v_cvt_pk_bf16_f32 v184, 0, v184
    v_cvt_pk_bf16_f32 v176, 0, v176
    v_rcp_f32 v185, v176
    v_sub_f32 v186, v186, v184
    v_cvt_pk_bf16_f32 v186, 0, v186
    v_mul_f32 v186, v186, v185
    v_cvt_pk_bf16_f32 v186, 0, v186
    s_waitcnt vmcnt(0)
    v_lshlrev_b32 v224, 16, v188
    v_and_b32 v225, 0xffff0000, v188
    v_lshlrev_b32 v226, 16, v189
    v_and_b32 v227, 0xffff0000, v189
    v_lshlrev_b32 v228, 16, v190
    v_and_b32 v229, 0xffff0000, v190
    v_lshlrev_b32 v230, 16, v191
    v_and_b32 v231, 0xffff0000, v191
    v_lshlrev_b32 v232, 16, v192
    v_and_b32 v233, 0xffff0000, v192
    v_lshlrev_b32 v234, 16, v193
    v_and_b32 v235, 0xffff0000, v193
    v_lshlrev_b32 v236, 16, v194
    v_and_b32 v237, 0xffff0000, v194
    v_lshlrev_b32 v238, 16, v195
    v_and_b32 v239, 0xffff0000, v195
    v_lshlrev_b32 v240, 16, v196
    v_and_b32 v241, 0xffff0000, v196
    v_lshlrev_b32 v242, 16, v197
    v_and_b32 v243, 0xffff0000, v197
    v_lshlrev_b32 v244, 16, v198
    v_and_b32 v245, 0xffff0000, v198
    v_lshlrev_b32 v246, 16, v199
    v_and_b32 v247, 0xffff0000, v199
    v_lshlrev_b32 v167, 16, v167
    v_and_b32 v12, 31, v1
    v_lshlrev_b32 v12, 3, v12
    ds_write_b64 v12, v[166:167] offset:19776
    v_mov_b32 v218, 0xbdd2d3e8
    v_mov_b32 v219, 0xc0135761
    s_mov_b32 s26, 0
    s_lshl_b32 s17, s14, 2
    v_mov_b32 v12, s17
L_mix:
    v_readlane_b32 s18, v186, s26
    s_nop 1
    v_mul_f32 v188, s18, v224
    v_mul_f32 v190, s18, v225
    v_mul_f32 v192, s18, v226
    v_mul_f32 v194, s18, v227
    v_mul_f32 v196, s18, v228
    v_mul_f32 v198, s18, v229
    v_mul_f32 v200, s18, v230
    v_mul_f32 v202, s18, v231
    v_cvt_pk_bf16_f32 v188, 0, v188
    v_cvt_pk_bf16_f32 v190, 0, v190
    v_cvt_pk_bf16_f32 v192, 0, v192
    v_cvt_pk_bf16_f32 v194, 0, v194
    v_cvt_pk_bf16_f32 v196, 0, v196
    v_cvt_pk_bf16_f32 v198, 0, v198
    v_cvt_pk_bf16_f32 v200, 0, v200
    v_cvt_pk_bf16_f32 v202, 0, v202
    v_add_f32 v188, v188, v232
    v_add_f32 v190, v190, v233
    v_add_f32 v192, v192, v234
    v_add_f32 v194, v194, v235
    v_add_f32 v196, v196, v236
    v_add_f32 v198, v198, v237
    v_add_f32 v200, v200, v238
    v_add_f32 v202, v202, v239
    v_cvt_pk_bf16_f32 v188, 0, v188
    v_cvt_pk_bf16_f32 v190, 0, v190
    v_cvt_pk_bf16_f32 v192, 0, v192
    v_cvt_pk_bf16_f32 v194, 0, v194
    v_cvt_pk_bf16_f32 v196, 0, v196
    v_cvt_pk_bf16_f32 v198, 0, v198
    v_cvt_pk_bf16_f32 v200, 0, v200
    v_cvt_pk_bf16_f32 v202, 0, v202
    v_mul_f32 v189, v188, v188
    v_mul_f32 v191, v190, v190
    v_mul_f32 v193, v192, v192
    v_mul_f32 v195, v194, v194
    v_mul_f32 v197, v196, v196
    v_mul_f32 v199, v198, v198
    v_mul_f32 v201, v200, v200
    v_mul_f32 v203, v202, v202
    v_fma_f32 v189, v189, v218, v219
    v_fma_f32 v191, v191, v218, v219
    v_fma_f32 v193, v193, v218, v219
    v_fma_f32 v195, v195, v218, v219
    v_fma_f32 v197, v197, v218, v219
    v_fma_f32 v199, v199, v218, v219
    v_fma_f32 v201, v201, v218, v219
    v_fma_f32 v203, v203, v218, v219
    v_mul_f32 v189, v189, v188
    v_mul_f32 v191, v191, v190
    v_mul_f32 v193, v193, v192
    v_mul_f32 v195, v195, v194
    v_mul_f32 v197, v197, v196
    v_mul_f32 v199, v199, v198
    v_mul_f32 v201, v201, v200
    v_mul_f32 v203, v203, v202
    v_exp_f32 v189, v189
    v_exp_f32 v191, v191
    v_exp_f32 v193, v193
    v_exp_f32 v195, v195
    v_exp_f32 v197, v197
    v_exp_f32 v199, v199
    v_exp_f32 v201, v201
    v_exp_f32 v203, v203
    v_add_f32 v189, 1.0, v189
    v_add_f32 v191, 1.0, v191
    v_add_f32 v193, 1.0, v193
    v_add_f32 v195, 1.0, v195
    v_add_f32 v197, 1.0, v197
    v_add_f32 v199, 1.0, v199
    v_add_f32 v201, 1.0, v201
    v_add_f32 v203, 1.0, v203
    v_rcp_f32 v189, v189
    v_rcp_f32 v191, v191
    v_rcp_f32 v193, v193
    v_rcp_f32 v195, v195
    v_rcp_f32 v197, v197
    v_rcp_f32 v199, v199
    v_rcp_f32 v201, v201
    v_rcp_f32 v203, v203
    v_mul_f32 v189, v189, v188
    v_mul_f32 v191, v191, v190
    v_mul_f32 v193, v193, v192
    v_mul_f32 v195, v195, v194
    v_mul_f32 v197, v197, v196
    v_mul_f32 v199, v199, v198
    v_mul_f32 v201, v201, v200
    v_mul_f32 v203, v203, v202
    v_cvt_pk_bf16_f32 v189, 0, v189
    v_cvt_pk_bf16_f32 v191, 0, v191
    v_cvt_pk_bf16_f32 v193, 0, v193
    v_cvt_pk_bf16_f32 v195, 0, v195
    v_cvt_pk_bf16_f32 v197, 0, v197
    v_cvt_pk_bf16_f32 v199, 0, v199
    v_cvt_pk_bf16_f32 v201, 0, v201
    v_cvt_pk_bf16_f32 v203, 0, v203
    v_mul_f32 v187, v189, v240
    v_fmac_f32 v187, v191, v241
    v_fmac_f32 v187, v193, v242
    v_fmac_f32 v187, v195, v243
    v_fmac_f32 v187, v197, v244
    v_fmac_f32 v187, v199, v245
    v_fmac_f32 v187, v201, v246
    v_fmac_f32 v187, v203, v247
    s_nop 1
    v_add_f32_dpp v187, v187, v187 quad_perm:[1,0,3,2] row_mask:0xf bank_mask:0xf
    s_nop 1
    v_add_f32_dpp v187, v187, v187 quad_perm:[2,3,0,1] row_mask:0xf bank_mask:0xf
    s_nop 1
    v_add_f32_dpp v187, v187, v187 row_half_mirror row_mask:0xf bank_mask:0xf
    s_nop 1
    v_add_f32_dpp v187, v187, v187 row_mirror row_mask:0xf bank_mask:0xf
    s_nop 1
    v_add_f32_dpp v187, v187, v187 row_bcast:15 row_mask:0xa bank_mask:0xf
    s_nop 1
    v_add_f32_dpp v187, v187, v187 row_bcast:31 row_mask:0xc bank_mask:0xf
    s_nop 0
    v_readlane_b32 s17, v187, 63
    s_nop 1
    v_mov_b32 v187, s17
    ds_write_b32 v12, v187 offset:20032
    v_add_u32 v12, 16, v12
    s_add_u32 s26, s26, 1
    s_cmp_lt_u32 s26, 32
    s_cbranch_scc1 L_mix
L_nomix:
    v_and_b32 v12, 3, v1
    v_mul_u32_u24 v12, 320, v12
    v_lshl_add_u32 v12, v6, 4, v12
    s_lshl_b32 s17, s21, 6
    s_lshl_b32 s18, s16, 4
    s_add_u32 s17, s17, s18
    s_lshl_b32 s17, s17, 11
    s_lshr_b32 s17, s17, 1
    s_lshl_b32 s18, s24, 6
    s_add_u32 s17, s17, s18
    v_and_b32 v216, 12, v1
    v_and_b32 v217, 3, v1
    v_lshl_add_u32 v216, v216, 6, v217
    v_lshl_add_u32 v217, v216, 4, s17
    s_cmp_lg_u32 s16, 1
    s_cbranch_scc1 L_noctl
L_ctl:
    s_cmp_lt_i32 s12, 0
    s_cbranch_scc1 L_tail
    s_mov_b32 s26, 2097152
L_pwait:
    s_sleep 6
    ds_read_b32 v188, v9 offset:19712
    s_sub_u32 s26, s26, 1
    s_cbranch_scc1 L_tail
    s_waitcnt lgkmcnt(0)
    v_cmp_gt_u32 vcc, s12, v188
    s_nop 1
    s_cbranch_vccnz L_pwait
    s_mov_b32 s18, 1
    s_atomic_add s18, s[56:57], s7 glc
    s_add_u32 s12, s12, 1
    s_waitcnt lgkmcnt(0)
    s_cmp_ge_u32 s18, 32
    s_addc_u32 s12, s12, 0
    s_cmp_ge_u32 s18, 44
    s_addc_u32 s12, s12, 0
    s_cmp_ge_u32 s18, 52
    s_addc_u32 s12, s12, 0
    s_cmp_ge_u32 s18, 58
    s_addc_u32 s12, s12, 0
    s_cmp_ge_u32 s18, 62
    s_addc_u32 s12, s12, 0
    v_mov_b32 v188, s12
    ds_write_b32 v9, v188 offset:19744
    s_ff1_i32_b64 s12, s[4:5]
    s_bitset0_b64 s[4:5], s12
    s_add_u32 s7, s7, 4224
    s_branch L_ctl
L_noctl:
    s_cmp_lg_u32 s16, 0
    s_cbranch_scc1 L_tail
    s_mov_b32 s26, 1048576
L_kwait:
    s_sleep 32
    ds_read_b128 v[188:191], v9 offset:19712
    s_sub_u32 s26, s26, 1
    s_cbranch_scc1 L_kwait_out
    s_waitcnt lgkmcnt(0)
    v_min_u32 v188, v188, v189
    v_min3_u32 v188, v190, v191, v188
    v_cmp_gt_u32 vcc, 32, v188
    s_nop 1
    s_cbranch_vccnz L_kwait
L_kwait_out:
    s_waitcnt lgkmcnt(0)
    s_mov_b32 s26, 4194304
L_rpoll:
    ds_read_b32 v220, v9 offset:19744
    s_sub_u32 s26, s26, 1
    s_cbranch_scc1 L_rdone
    s_waitcnt vmcnt(0) lgkmcnt(0)
    v_cmp_gt_u32 vcc, 1, v220
    s_nop 1
    s_cbranch_vccnz L_rpoll
L_rdone:
    s_waitcnt vmcnt(0) lgkmcnt(0)
    s_mul_i32 s17, s21, 270336
    s_add_u32 s17, s17, 1048576
    v_mov_b32 v10, s17
    global_load_dword v220, v10, s[56:57] sc1
    s_mov_b32 s18, 0x3db504f3
    s_mov_b32 s15, 0x3fb8aa3b
    s_mov_b32 s26, 0
    v_mov_b32 v13, v3
    v_mov_b32 v206, 0
    v_mov_b32 v207, 0
L_stat:
    ds_read_b128 v[188:191], v13 offset:0
    ds_read_b128 v[192:195], v13 offset:1024
    ds_read_b128 v[196:199], v13 offset:2048
    ds_read_b128 v[200:203], v13 offset:3072
    v_add_u32 v13, 4096, v13
    s_waitcnt lgkmcnt(0)
    v_max3_f32 v204, v188, v189, v190
    v_max3_f32 v204, v191, v192, v204
    v_max3_f32 v204, v193, v194, v204
    v_max3_f32 v204, v195, v196, v204
    v_max3_f32 v204, v197, v198, v204
    v_max3_f32 v204, v199, v200, v204
    v_max3_f32 v204, v201, v202, v204
    v_max_f32 v204, v203, v204
    s_nop 1
    v_max_f32_dpp v204, v204, v204 quad_perm:[1,0,3,2] row_mask:0xf bank_mask:0xf
    s_nop 1
    v_max_f32_dpp v204, v204, v204 quad_perm:[2,3,0,1] row_mask:0xf bank_mask:0xf
    s_nop 1
    v_max_f32_dpp v204, v204, v204 row_half_mirror row_mask:0xf bank_mask:0xf
    s_nop 1
    v_max_f32_dpp v204, v204, v204 row_mirror row_mask:0xf bank_mask:0xf
    s_nop 1
    v_max_f32_dpp v204, v204, v204 row_bcast:15 row_mask:0xa bank_mask:0xf
    s_nop 1
    v_max_f32_dpp v204, v204, v204 row_bcast:31 row_mask:0xc bank_mask:0xf
    s_nop 0
    v_readlane_b32 s17, v204, 63
    s_nop 1
    v_cvt_pk_bf16_f32 v204, 0, s17
    v_mul_f32 v204, s18, v204
    v_cvt_pk_bf16_f32 v204, 0, v204
    v_mul_f32 v204, s15, v204
    v_cvt_pk_bf16_f32 v188, 0, v188
    v_cvt_pk_bf16_f32 v189, 0, v189
    v_cvt_pk_bf16_f32 v190, 0, v190
    v_cvt_pk_bf16_f32 v191, 0, v191
    v_cvt_pk_bf16_f32 v192, 0, v192
    v_cvt_pk_bf16_f32 v193, 0, v193
    v_cvt_pk_bf16_f32 v194, 0, v194
    v_cvt_pk_bf16_f32 v195, 0, v195
    v_cvt_pk_bf16_f32 v196, 0, v196
    v_cvt_pk_bf16_f32 v197, 0, v197
    v_cvt_pk_bf16_f32 v198, 0, v198
    v_cvt_pk_bf16_f32 v199, 0, v199
    v_cvt_pk_bf16_f32 v200, 0, v200
    v_cvt_pk_bf16_f32 v201, 0, v201
    v_cvt_pk_bf16_f32 v202, 0, v202
    v_cvt_pk_bf16_f32 v203, 0, v203
    v_mul_f32 v188, s18, v188
    v_mul_f32 v189, s18, v189
    v_mul_f32 v190, s18, v190
    v_mul_f32 v191, s18, v191
    v_mul_f32 v192, s18, v192
    v_mul_f32 v193, s18, v193
    v_mul_f32 v194, s18, v194
    v_mul_f32 v195, s18, v195
    v_mul_f32 v196, s18, v196
    v_mul_f32 v197, s18, v197
    v_mul_f32 v198, s18, v198
    v_mul_f32 v199, s18, v199
    v_mul_f32 v200, s18, v200
    v_mul_f32 v201, s18, v201
    v_mul_f32 v202, s18, v202
    v_mul_f32 v203, s18, v203
    v_cvt_pk_bf16_f32 v188, 0, v188
    v_cvt_pk_bf16_f32 v189, 0, v189
    v_cvt_pk_bf16_f32 v190, 0, v190
    v_cvt_pk_bf16_f32 v191, 0, v191
    v_cvt_pk_bf16_f32 v192, 0, v192
    v_cvt_pk_bf16_f32 v193, 0, v193
    v_cvt_pk_bf16_f32 v194, 0, v194
    v_cvt_pk_bf16_f32 v195, 0, v195
    v_cvt_pk_bf16_f32 v196, 0, v196
    v_cvt_pk_bf16_f32 v197, 0, v197
    v_cvt_pk_bf16_f32 v198, 0, v198
    v_cvt_pk_bf16_f32 v199, 0, v199
    v_cvt_pk_bf16_f32 v200, 0, v200
    v_cvt_pk_bf16_f32 v201, 0, v201
    v_cvt_pk_bf16_f32 v202, 0, v202
    v_cvt_pk_bf16_f32 v203, 0, v203
    v_fma_f32 v188, v188, s15, -v204
    v_fma_f32 v189, v189, s15, -v204
    v_fma_f32 v190, v190, s15, -v204
    v_fma_f32 v191, v191, s15, -v204
    v_fma_f32 v192, v192, s15, -v204
    v_fma_f32 v193, v193, s15, -v204
    v_fma_f32 v194, v194, s15, -v204
    v_fma_f32 v195, v195, s15, -v204
    v_fma_f32 v196, v196, s15, -v204
    v_fma_f32 v197, v197, s15, -v204
    v_fma_f32 v198, v198, s15, -v204
    v_fma_f32 v199, v199, s15, -v204
    v_fma_f32 v200, v200, s15, -v204
    v_fma_f32 v201, v201, s15, -v204
    v_fma_f32 v202, v202, s15, -v204
    v_fma_f32 v203, v203, s15, -v204
    v_exp_f32 v188, v188
    v_exp_f32 v189, v189
    v_exp_f32 v190, v190
    v_exp_f32 v191, v191
    v_exp_f32 v192, v192
    v_exp_f32 v193, v193
    v_exp_f32 v194, v194
    v_exp_f32 v195, v195
    v_exp_f32 v196, v196
    v_exp_f32 v197, v197
    v_exp_f32 v198, v198
    v_exp_f32 v199, v199
    v_exp_f32 v200, v200
    v_exp_f32 v201, v201
    v_exp_f32 v202, v202
    v_exp_f32 v203, v203
    v_add_f32 v188, v188, v196
    v_add_f32 v189, v189, v197
    v_add_f32 v190, v190, v198
    v_add_f32 v191, v191, v199
    v_add_f32 v192, v192, v200
    v_add_f32 v193, v193, v201
    v_add_f32 v194, v194, v202
    v_add_f32 v195, v195, v203
    v_add_f32 v188, v188, v192
    v_add_f32 v189, v189, v193
    v_add_f32 v190, v190, v194
    v_add_f32 v191, v191, v195
    v_add_f32 v188, v188, v190
    v_add_f32 v189, v189, v191
    v_add_f32 v188, v188, v189
    s_nop 1
    v_add_f32_dpp v188, v188, v188 quad_perm:[1,0,3,2] row_mask:0xf bank_mask:0xf
    s_nop 1
    v_add_f32_dpp v188, v188, v188 quad_perm:[2,3,0,1] row_mask:0xf bank_mask:0xf
    s_nop 1
    v_add_f32_dpp v188, v188, v188 row_half_mirror row_mask:0xf bank_mask:0xf
    s_nop 1
    v_add_f32_dpp v188, v188, v188 row_mirror row_mask:0xf bank_mask:0xf
    s_nop 1
    v_add_f32_dpp v188, v188, v188 row_bcast:15 row_mask:0xa bank_mask:0xf
    s_nop 1
    v_add_f32_dpp v188, v188, v188 row_bcast:31 row_mask:0xc bank_mask:0xf
    s_nop 0
    v_readlane_b32 s17, v188, 63
    v_and_b32 v205, 3, v1
    v_cmp_eq_u32 vcc, s26, v205
    v_mov_b32 v205, s17
    s_nop 0
    v_cndmask_b32 v206, v206, v204, vcc
    v_cndmask_b32 v207, v207, v205, vcc
    s_add_u32 s26, s26, 1
    s_cmp_lt_u32 s26, 4
    s_cbranch_scc1 L_stat
    v_mov_b32 v208, v206
    s_nop 1
    v_max_f32_dpp v208, v208, v208 quad_perm:[1,0,3,2] row_mask:0xf bank_mask:0xf
    s_nop 1
    v_max_f32_dpp v208, v208, v208 quad_perm:[2,3,0,1] row_mask:0xf bank_mask:0xf
    v_sub_f32 v209, v206, v208
    v_exp_f32 v209, v209
    s_nop 0
    v_mul_f32 v209, v209, v207
    s_nop 1
    v_add_f32_dpp v209, v209, v209 quad_perm:[1,0,3,2] row_mask:0xf bank_mask:0xf
    s_nop 1
    v_add_f32_dpp v209, v209, v209 quad_perm:[2,3,0,1] row_mask:0xf bank_mask:0xf
    s_mov_b32 s26, 262144
L_cpoll:
    s_waitcnt vmcnt(0)
    v_cmp_gt_u32 vcc, 64, v220
    s_nop 1
    s_cbranch_vccz L_cdone
    global_load_dword v220, v10, s[56:57] sc1
    s_sub_u32 s26, s26, 1
    s_cbranch_scc0 L_cpoll
L_cdone:
    s_lshl_b32 s17, s2, 7
    s_add_u32 s17, s17, 524288
    v_mov_b32 v210, s17
    v_xor_b32 v211, 0x1000, v210
    v_min_u32 v208, -2, v208
    v_min_u32 v209, -2, v209
    s_mov_b64 exec, 1
    global_store_dwordx2 v210, v[208:209], s[56:57] sc1
    s_mov_b64 exec, -1
    s_mov_b32 s26, 1048576
L_vwait:
    s_sleep 32
    ds_read_b128 v[188:191], v9 offset:19712
    s_sub_u32 s26, s26, 1
    s_cbranch_scc1 L_vwait_out
    s_waitcnt lgkmcnt(0)
    v_min_u32 v188, v188, v189
    v_min3_u32 v188, v190, v191, v188
    v_cmp_gt_u32 vcc, 52, v188
    s_nop 1
    s_cbranch_vccnz L_vwait
L_vwait_out:
    s_waitcnt lgkmcnt(0)
    s_mov_b32 s26, 262144
L_mpoll:
    global_load_dwordx2 v[212:213], v211, s[56:57] sc1
    s_sub_u32 s26, s26, 1
    s_cbranch_scc1 L_mdone
    s_waitcnt vmcnt(0)
    v_max_u32 v214, v212, v213
    v_cmp_eq_u32 vcc, -1, v214
    s_nop 1
    s_cbranch_vccnz L_mpoll
L_mdone:
    s_waitcnt vmcnt(0)
    v_max_f32 v214, v208, v212
    v_sub_f32 v208, v208, v214
    v_sub_f32 v212, v212, v214
    v_sub_f32 v206, v206, v214
    v_exp_f32 v208, v208
    v_exp_f32 v212, v212
    v_exp_f32 v206, v206
    v_mul_f32 v209, v208, v209
    v_fmac_f32 v209, v212, v213
    v_rcp_f32 v209, v209
    v_and_b32 v205, 3, v1
    v_lshlrev_b32 v205, 2, v205
    v_mul_f32 v206, v206, v209
    ds_write_b32 v205, v206 offset:19728
L_tail:
    s_setprio 3
    s_waitcnt lgkmcnt(0)
    s_barrier
    ds_read_b128 v[192:195], v12 offset:18432
    ds_read_b128 v[196:199], v12 offset:18496
    ds_read_b128 v[200:203], v12 offset:18560
    ds_read_b128 v[204:207], v12 offset:18624
    ds_read_b128 v[220:223], v9 offset:19728
    s_waitcnt lgkmcnt(4)
    v_mfma_f32_16x16x32_bf16 v[160:163], v[192:195], v[32:35], 0
    s_waitcnt lgkmcnt(3)
    v_mfma_f32_16x16x32_bf16 v[160:163], v[196:199], v[36:39], v[160:163]
    s_waitcnt lgkmcnt(2)
    v_mfma_f32_16x16x32_bf16 v[160:163], v[200:203], v[40:43], v[160:163]
    s_waitcnt lgkmcnt(1)
    v_mfma_f32_16x16x32_bf16 v[160:163], v[204:207], v[44:47], v[160:163]
    v_mfma_f32_16x16x32_bf16 v[164:167], v[192:195], v[48:51], 0
    s_waitcnt lgkmcnt(0)
    v_mfma_f32_16x16x32_bf16 v[164:167], v[196:199], v[52:55], v[164:167]
    v_mfma_f32_16x16x32_bf16 v[164:167], v[200:203], v[56:59], v[164:167]
    v_mfma_f32_16x16x32_bf16 v[164:167], v[204:207], v[60:63], v[164:167]
    v_mfma_f32_16x16x32_bf16 v[168:171], v[192:195], v[64:67], 0
    v_mfma_f32_16x16x32_bf16 v[168:171], v[196:199], v[68:71], v[168:171]
    v_mfma_f32_16x16x32_bf16 v[168:171], v[200:203], v[72:75], v[168:171]
    v_mul_f32 v208, v220, v160
    v_fmac_f32 v208, v221, v161
    v_mfma_f32_16x16x32_bf16 v[168:171], v[204:207], v[76:79], v[168:171]
    v_fmac_f32 v208, v222, v162
    v_fmac_f32 v208, v223, v163
    v_mfma_f32_16x16x32_bf16 v[172:175], v[192:195], v[80:83], 0
    v_mul_f32 v209, v220, v164
    v_fmac_f32 v209, v221, v165
    v_mfma_f32_16x16x32_bf16 v[172:175], v[196:199], v[84:87], v[172:175]
    v_fmac_f32 v209, v222, v166
    v_fmac_f32 v209, v223, v167
    v_mfma_f32_16x16x32_bf16 v[172:175], v[200:203], v[88:91], v[172:175]
    v_cvt_pk_bf16_f32 v224, v208, v209
    v_mfma_f32_16x16x32_bf16 v[172:175], v[204:207], v[92:95], v[172:175]
    v_min_u32 v224, -2, v224
    v_mfma_f32_16x16x32_bf16 v[176:179], v[192:195], v[96:99], 0
    v_mul_f32 v210, v220, v168
    v_mfma_f32_16x16x32_bf16 v[176:179], v[196:199], v[100:103], v[176:179]
    v_fmac_f32 v210, v221, v169
    v_mfma_f32_16x16x32_bf16 v[176:179], v[200:203], v[104:107], v[176:179]
    v_fmac_f32 v210, v222, v170
    v_mfma_f32_16x16x32_bf16 v[176:179], v[204:207], v[108:111], v[176:179]
    v_fmac_f32 v210, v223, v171
    v_mfma_f32_16x16x32_bf16 v[180:183], v[192:195], v[112:115], 0
    v_mul_f32 v211, v220, v172
    v_fmac_f32 v211, v221, v173
    v_mfma_f32_16x16x32_bf16 v[180:183], v[196:199], v[116:119], v[180:183]
    v_fmac_f32 v211, v222, v174
    v_fmac_f32 v211, v223, v175
    v_mfma_f32_16x16x32_bf16 v[180:183], v[200:203], v[120:123], v[180:183]
    v_cvt_pk_bf16_f32 v225, v210, v211
    v_mfma_f32_16x16x32_bf16 v[180:183], v[204:207], v[124:127], v[180:183]
    v_min_u32 v225, -2, v225
    v_mfma_f32_16x16x32_bf16 v[184:187], v[192:195], v[128:131], 0
    v_mul_f32 v212, v220, v176
    v_mfma_f32_16x16x32_bf16 v[184:187], v[196:199], v[132:135], v[184:187]
    v_fmac_f32 v212, v221, v177
    v_mfma_f32_16x16x32_bf16 v[184:187], v[200:203], v[136:139], v[184:187]
    v_fmac_f32 v212, v222, v178
    v_mfma_f32_16x16x32_bf16 v[184:187], v[204:207], v[140:143], v[184:187]
    v_fmac_f32 v212, v223, v179
    v_mfma_f32_16x16x32_bf16 v[188:191], v[192:195], v[144:147], 0
    v_mul_f32 v213, v220, v180
    v_fmac_f32 v213, v221, v181
    v_mfma_f32_16x16x32_bf16 v[188:191], v[196:199], v[148:151], v[188:191]
    v_fmac_f32 v213, v222, v182
    v_fmac_f32 v213, v223, v183
    v_mfma_f32_16x16x32_bf16 v[188:191], v[200:203], v[152:155], v[188:191]
    v_cvt_pk_bf16_f32 v226, v212, v213
    v_mfma_f32_16x16x32_bf16 v[188:191], v[204:207], v[156:159], v[188:191]
    v_min_u32 v226, -2, v226
    v_mul_f32 v214, v220, v184
    v_fmac_f32 v214, v221, v185
    v_fmac_f32 v214, v222, v186
    v_fmac_f32 v214, v223, v187
    s_nop 2
    v_mul_f32 v215, v220, v188
    v_fmac_f32 v215, v221, v189
    v_fmac_f32 v215, v222, v190
    v_fmac_f32 v215, v223, v191
    v_cvt_pk_bf16_f32 v227, v214, v215
    v_min_u32 v227, -2, v227
    s_mov_b64 exec, 0xffff
    global_store_dwordx4 v217, v[224:227], s[56:57] sc1
    s_endpgm
.section .rodata,"a"
.p2align 6
.amdhsa_kernel parallel_sum__gqa_block_cached__mixer_token_mlp__decode_kernel
  .amdhsa_next_free_vgpr 256
  .amdhsa_next_free_sgpr 96
  .amdhsa_accum_offset 256
  .amdhsa_group_segment_fixed_size 0
  .amdhsa_kernarg_size 104
  .amdhsa_user_sgpr_count 2
  .amdhsa_user_sgpr_kernarg_segment_ptr 1
  .amdhsa_system_sgpr_workgroup_id_x 1
  .amdhsa_float_denorm_mode_32 3
.end_amdhsa_kernel
```
